```python
import torch

def _softmax(x, axis=-1):
    return torch.softmax(x, dim=axis)
def _gelu(x):
    return torch.nn.functional.gelu(x, approximate="tanh")
def _silu(x):
    return torch.nn.functional.silu(x)
def _sigmoid(x):
    return torch.sigmoid(x)
def _layernorm(x, axis=-1, eps=1e-5):
    m = x.mean(dim=axis, keepdim=True)
    v = x.var(dim=axis, keepdim=True, unbiased=False)
    return (x - m) / torch.sqrt(v + eps)
def _scatter_add(tgt, idx, src, axis=0):
    return tgt.clone().index_add_(axis, idx, src)
def _segment_sum(src, seg, n):
    out = torch.zeros((n,) + src.shape[1:], dtype=src.dtype)
    return out.index_add_(0, seg, src)
def _pad(x, pw):
    flat = tuple(v for pair in reversed(pw) for v in pair)
    return torch.nn.functional.pad(x, flat)

kernel_name = 'concat_heads__ssm_conv_s4__ssm_conv_s5__prompt'

def setup_inputs():

    _w = (lambda a: (lambda t: t.to(torch.bfloat16) if t.is_floating_point() else t)(torch.as_tensor(a)))
    def _A_setup():
        B, L, D, N = 1, 2048, 576, 128
        A_re = -(lambda _x: torch.exp(torch.as_tensor(_x)))((lambda *s: torch.randn(*s, dtype=torch.bfloat16) * 3.2)(D, N))
        A_im = torch.pi * (lambda *s: torch.randn(*s, dtype=torch.bfloat16) * 0.05)(D, N)
        B_re = (lambda *s: torch.randn(*s, dtype=torch.bfloat16) * 0.1)(D, N)
        B_im = (lambda *s: torch.randn(*s, dtype=torch.bfloat16) * 0.1)(D, N)
        C_re = (lambda *s: torch.randn(*s, dtype=torch.bfloat16) * 0.1)(D, N)
        C_im = (lambda *s: torch.randn(*s, dtype=torch.bfloat16) * 0.1)(D, N)
        log_dt = (lambda *s: torch.randn(*s, dtype=torch.bfloat16) * 0.05)(D) * 0.5 - 4.0
        Dskip = (lambda *s: torch.randn(*s, dtype=torch.bfloat16) * 0.05)(D)
        return {
            "u": _w((lambda *s: torch.randn(*s, dtype=torch.bfloat16) * 0.05)(B, L, D)),
            "A_re": _w(A_re),
            "A_im": _w(A_im),
            "B_re": _w(B_re),
            "B_im": _w(B_im),
            "C_re": _w(C_re),
            "C_im": _w(C_im),
            "log_dt": _w(log_dt),
            "Dskip": _w(Dskip),
        }
    _A_in = _A_setup()

    def _B_setup():
        B, S, D = 1, 2048, 576
        P = D
        Lambda_re = -0.5 * (lambda _x: torch.exp(torch.as_tensor(_x)))((lambda *s: torch.randn(*s, dtype=torch.bfloat16) * 0.2)(P))
        Lambda_im = (lambda *s: torch.randn(*s, dtype=torch.bfloat16) * 0.4)(P) * 1.0
        B_re = (lambda *s: torch.randn(*s, dtype=torch.bfloat16) * 0.2)(P, D) * (D ** -0.5)
        B_im = (lambda *s: torch.randn(*s, dtype=torch.bfloat16) * 0.2)(P, D) * (D ** -0.5)
        C_re = (lambda *s: torch.randn(*s, dtype=torch.bfloat16) * 0.2)(D, P) * (P ** -0.5)
        C_im = (lambda *s: torch.randn(*s, dtype=torch.bfloat16) * 0.2)(D, P) * (P ** -0.5)
        log_dt = (lambda *s: torch.randn(*s, dtype=torch.bfloat16) * 0.2)(P) * 0.3 - 2.0
        Dskip = (lambda *s: torch.randn(*s, dtype=torch.bfloat16) * 0.05)(D)
        return {
            "x": _w((lambda *s: torch.randn(*s, dtype=torch.bfloat16) * 0.05)(B, S, D)),
            "Lambda_re": _w(Lambda_re),
            "Lambda_im": _w(Lambda_im),
            "B_re": _w(B_re),
            "B_im": _w(B_im),
            "C_re": _w(C_re),
            "C_im": _w(C_im),
            "log_dt": _w(log_dt),
            "Dskip": _w(Dskip),
        }
    _B_in = _B_setup()

    return {
        "A_u": _A_in["u"],
        "A_A_re": _A_in["A_re"],
        "A_A_im": _A_in["A_im"],
        "A_B_re": _A_in["B_re"],
        "A_B_im": _A_in["B_im"],
        "A_C_re": _A_in["C_re"],
        "A_C_im": _A_in["C_im"],
        "A_log_dt": _A_in["log_dt"],
        "A_Dskip": _A_in["Dskip"],
        "B_x": _B_in["x"],
        "B_Lambda_re": _B_in["Lambda_re"],
        "B_Lambda_im": _B_in["Lambda_im"],
        "B_B_re": _B_in["B_re"],
        "B_B_im": _B_in["B_im"],
        "B_C_re": _B_in["C_re"],
        "B_C_im": _B_in["C_im"],
        "B_log_dt": _B_in["log_dt"],
        "B_Dskip": _B_in["Dskip"],
    }

def reference(A_u, A_A_re, A_A_im, A_B_re, A_B_im, A_C_re, A_C_im, A_log_dt, A_Dskip, B_x, B_Lambda_re, B_Lambda_im, B_B_re, B_B_im, B_C_re, B_C_im, B_log_dt, B_Dskip):
    def _A_ref(u, A_re, A_im, B_re, B_im, C_re, C_im, log_dt, Dskip):
        Bsz, L, D = u.shape
        dt = torch.exp(log_dt)[:, None]
        A = A_re + 1j * A_im
        Bc = B_re + 1j * B_im
        Cc = C_re + 1j * C_im
        logdA = dt * A
        dB = dt * Bc
        l = (lambda x, dt: x.to(dt))(torch.arange(L), A_re.dtype)
        P = torch.exp(logdA[:, :, None] * l[None, None, :])
        K = torch.einsum("dn,dnl,dn->dl", Cc, P, dB).real
        L2 = 2 * L
        Kp = _pad(K, ((0, 0), (0, L)))
        up = (lambda x, *d: x.permute(*d))(u, 0, 2, 1)
        up = _pad(up, ((0, 0), (0, 0), (0, L)))
        Kf = (lambda x, axes=(-2,-1): torch.fft.rfft2(x.float(), dim=axes))(Kp[:, None, :], axes=(-2, -1))
        Uf = (lambda x, axes=(-2,-1): torch.fft.rfft2(x.float(), dim=axes))(up[:, :, None, :], axes=(-2, -1))
        Yf = Uf * Kf[None, :, :, :]
        y = (lambda x, s, axes=(-2,-1): torch.fft.irfft2(x, s=s, dim=axes).to(torch.bfloat16))(Yf, (1, L2), axes=(-2, -1))[:, :, 0, :L]
        y = (lambda x, *d: x.permute(*d))(y, 0, 2, 1) + u * Dskip[None, None, :]
        return y

    def _B_ref(x, Lambda_re, Lambda_im, B_re, B_im, C_re, C_im, log_dt, Dskip):
        Bsz, L, H = x.shape
        Lam = Lambda_re + 1j * Lambda_im
        Bmat = B_re + 1j * B_im
        Cmat = C_re + 1j * C_im
        dt = torch.exp(log_dt)
        Lam_bar = torch.exp(dt * Lam)
        B_bar = ((Lam_bar - 1.0) / Lam)[:, None] * Bmat
        Bu = torch.einsum("bld,pd->blp", x + 0j, B_bar)
        h = torch.zeros_like(Bu[:, 0, :])
        hs = []
        for t in range(L):
            h = Lam_bar[None, :] * h + Bu[:, t, :]
            hs.append(h)
        hseq = torch.stack(hs, 1)
        y = 2.0 * torch.einsum("blp,dp->bld", hseq, Cmat).real + x * Dskip[None, None, :]
        return y

    a = _A_ref(A_u, A_A_re, A_A_im, A_B_re, A_B_im, A_C_re, A_C_im, A_log_dt, A_Dskip)
    b = _B_ref(B_x, B_Lambda_re, B_Lambda_im, B_B_re, B_B_im, B_C_re, B_C_im, B_log_dt, B_Dskip)
    return torch.concatenate([a, b], axis=-1)
```

```asm
; @launch grid=(256,1,1) block=(512,1,1) lds=163840
.amdgcn_target "amdgcn-amd-amdhsa--gfx950"
.text
.p2align 8
.globl concat_heads__ssm_conv_s4__ssm_conv_s5__prompt_kernel
.type concat_heads__ssm_conv_s4__ssm_conv_s5__prompt_kernel,@function
concat_heads__ssm_conv_s4__ssm_conv_s5__prompt_kernel:
    v_lshrrev_b32 v2, 6, v0
    v_and_b32 v1, 63, v0
    s_cmp_lt_u32 s2, 144
    v_readfirstlane_b32 s3, v2
    s_nop 4
    s_cbranch_scc1 L_brole
    s_cmp_ge_u32 s2, 216
    s_cbranch_scc1 L_e1
    s_load_dwordx16 s[8:23], s[0:1], 0
    s_load_dwordx2 s[24:25], s[0:1], 64
    s_sub_u32 s4, s2, 144
    s_and_b32 s5, s4, 7
    s_lshr_b32 s6, s4, 3
    s_mul_i32 s5, s5, 9
    s_add_u32 s5, s5, s6
    s_lshl_b32 s7, s5, 3
    s_add_u32 s7, s7, s3
    s_lshl_b32 s33, s7, 8
    v_lshl_add_u32 v5, v1, 2, s33
    s_lshl_b32 s33, s7, 1
    v_mov_b32 v6, s33
    s_waitcnt lgkmcnt(0)
    global_load_dword v10, v5, s[10:11]
    global_load_dword v11, v5, s[12:13]
    global_load_dword v12, v5, s[14:15]
    global_load_dword v13, v5, s[16:17]
    global_load_dword v14, v5, s[18:19]
    global_load_dword v15, v5, s[20:21]
    global_load_ushort v16, v6, s[22:23]
    global_load_ushort v17, v6, s[24:25]
    s_load_dwordx4 s[28:31], s[0:1], 144
    s_load_dwordx2 s[26:27], s[0:1], 160
    s_branch L_arole
L_e1:
    s_cmp_ge_u32 s2, 256
    s_cbranch_scc1 L_end
    s_getpc_b64 s[40:41]
L_pc:
    v_lshlrev_b32 v3, 7, v0
    v_min_u32 v3, L_codeend-concat_heads__ssm_conv_s4__ssm_conv_s5__prompt_kernel-4, v3
    s_sub_u32 s40, s40, L_pc-concat_heads__ssm_conv_s4__ssm_conv_s5__prompt_kernel
    s_subb_u32 s41, s41, 0
    v_mov_b32 v5, 0
    v_mov_b32 v4, v3
    v_lshl_add_u64 v[4:5], v[4:5], 0, s[40:41]
    global_load_dword v255, v[4:5], off
    s_branch L_trole
L_brole:
    s_load_dwordx2 s[20:21], s[0:1], 72
    s_load_dwordx8 s[28:35], s[0:1], 96
    s_load_dwordx2 s[22:23], s[0:1], 160
    s_load_dwordx4 s[24:27], s[0:1], 80
    s_load_dwordx8 s[36:43], s[0:1], 128
    s_and_b32 s4, s2, 7
    s_lshr_b32 s5, s2, 3
    s_cmp_ge_u32 s5, 9
    s_cselect_b32 s6, 1, 0
    s_lshl_b32 s4, s4, 1
    s_add_u32 s4, s4, s6
    s_mul_i32 s7, s6, 9
    s_sub_u32 s5, s5, s7
    s_add_u32 s6, s5, s4
    s_cmp_ge_u32 s6, 9
    s_cselect_b32 s7, 9, 0
    s_sub_u32 s6, s6, s7
    s_cmp_ge_u32 s6, 9
    s_cselect_b32 s7, 9, 0
    s_sub_u32 s6, s6, s7
    s_cmp_lt_u32 s3, 4
    s_cbranch_scc1 L_bcomp
    s_sub_u32 s44, s3, 4
    s_mov_b32 s45, 1152
    v_lshrrev_b32 v3, 4, v1
    v_and_b32 v4, 7, v1
    v_xor_b32 v4, v4, v3
    v_lshlrev_b32 v4, 4, v4
    v_xor_b32 v5, 64, v4
    v_lshrrev_b32 v6, 5, v1
    v_lshlrev_b32 v6, 5, v6
    v_bfe_u32 v7, v1, 3, 1
    v_lshl_add_u32 v6, v7, 4, v6
    v_bfe_u32 v7, v1, 4, 1
    v_add_u32 v6, v6, v7
    s_lshl_b32 s46, s4, 7
    s_lshl_b32 s47, s44, 2
    s_add_u32 s46, s46, s47
    v_add_u32 v6, s46, v6
    v_mul_lo_u32 v6, v6, s45
    v_add_u32 v24, v6, v4
    v_add_u32 v25, v6, v5
    v_add_u32 v25, 73728, v25
    v_add_u32 v26, v6, v4
    v_add_u32 v26, 2304, v26
    v_add_u32 v27, v6, v5
    v_add_u32 v27, 76032, v27
    s_lshl_b32 s46, s5, 6
    s_and_b32 s47, s44, 1
    s_lshl_b32 s47, s47, 5
    s_add_u32 s47, s46, s47
    v_lshrrev_b32 v6, 3, v1
    v_add_u32 v6, s47, v6
    v_mul_lo_u32 v6, v6, s45
    v_add_u32 v28, v6, v4
    v_add_u32 v29, v6, v5
    v_add_u32 v29, 9216, v29
    v_add_u32 v30, v6, v4
    v_add_u32 v30, 18432, v30
    v_add_u32 v31, v6, v5
    v_add_u32 v31, 27648, v31
    s_lshl_b32 s50, s44, 12
    s_mov_b32 s63, s6
    s_add_u32 s62, s5, 9
    s_sub_u32 s62, s62, s63
    s_cmp_ge_u32 s62, 9
    s_cselect_b32 s52, 9, 0
    s_sub_u32 s62, s62, s52
    s_waitcnt lgkmcnt(0)
    s_mov_b32 s8, s20
    s_and_b32 s9, s21, 0xffff
    s_mov_b32 s10, 0x240000
    s_mov_b32 s11, 0x00020000
    s_cmp_ge_u32 s44, 2
    s_cselect_b32 s48, s30, s28
    s_cselect_b32 s49, s31, s29
    s_mov_b32 s12, s48
    s_and_b32 s13, s49, 0xffff
    s_mov_b32 s14, 0xa2000
    s_mov_b32 s15, 0x00020000
    s_cmp_le_u32 s62, 0
    s_addc_u32 s51, s63, 0
    s_cmp_ge_u32 s51, 9
    s_cselect_b32 s52, 9, 0
    s_sub_u32 s51, s51, s52
    s_lshl_b32 s51, s51, 7
    s_add_u32 m0, s50, 0
    s_nop 0
    buffer_load_dwordx4 v24, s[8:11], s51 offen lds
    s_add_u32 m0, s50, 1024
    s_nop 0
    buffer_load_dwordx4 v25, s[8:11], s51 offen lds
    s_add_u32 m0, s50, 2048
    s_nop 0
    buffer_load_dwordx4 v26, s[8:11], s51 offen lds
    s_add_u32 m0, s50, 3072
    s_nop 0
    buffer_load_dwordx4 v27, s[8:11], s51 offen lds
    s_add_u32 m0, s50, 16384
    s_nop 0
    buffer_load_dwordx4 v28, s[12:15], s51 offen lds
    s_add_u32 m0, s50, 17408
    s_nop 0
    buffer_load_dwordx4 v29, s[12:15], s51 offen lds
    s_add_u32 m0, s50, 18432
    s_nop 0
    buffer_load_dwordx4 v30, s[12:15], s51 offen lds
    s_add_u32 m0, s50, 19456
    s_nop 0
    buffer_load_dwordx4 v31, s[12:15], s51 offen lds
    s_mov_b32 s16, s22
    s_and_b32 s17, s23, 0xffff
    s_mov_b32 s18, 0x10000000
    s_mov_b32 s19, 0x00020000
    v_mov_b32 v2, 0
    buffer_load_dword v18, v2, s[16:19], 0 offen sc1
    s_barrier
    v_and_b32 v2, 31, v1
    s_lshl_b32 s76, s5, 6
    s_lshr_b32 s77, s3, 2
    s_lshl_b32 s78, s77, 5
    s_add_u32 s76, s76, s78
    v_add_u32 v56, s76, v2
    v_lshlrev_b32 v21, 1, v56
    global_load_ushort v20, v21, s[38:39]
    s_lshl_b32 s76, s4, 7
    s_and_b32 s78, s3, 3
    s_lshl_b32 s79, s78, 5
    s_add_u32 s76, s76, s79
    v_lshrrev_b32 v57, 5, v1
    v_lshl_add_u32 v15, v57, 2, s76
    s_movk_i32 s76, 4608
    v_mul_lo_u32 v15, v15, s76
    v_lshl_add_u32 v15, v56, 2, v15
    v_add_u32 v15, 2304, v15
    v_bfe_u32 v21, v2, 1, 3
    v_lshlrev_b32 v21, 4, v21
    s_lshl_b32 s78, s78, 2
    v_add_u32 v21, s78, v21
    v_and_b32 v56, 1, v2
    v_lshl_add_u32 v21, v56, 1, v21
    v_lshrrev_b32 v56, 4, v2
    v_add_u32 v21, v21, v56
    v_bfe_u32 v56, v21, 1, 3
    s_lshl_b32 s77, s77, 2
    v_add_u32 v57, s77, v57
    v_xor_b32 v56, v56, v57
    v_lshlrev_b32 v56, 4, v56
    v_lshl_add_u32 v21, v21, 7, v56
    s_cmp_le_u32 s62, 1
    s_addc_u32 s51, s63, 1
    s_cmp_ge_u32 s51, 9
    s_cselect_b32 s52, 9, 0
    s_sub_u32 s51, s51, s52
    s_lshl_b32 s51, s51, 7
    s_add_u32 m0, s50, 32768
    s_nop 0
    buffer_load_dwordx4 v24, s[8:11], s51 offen lds
    s_add_u32 m0, s50, 33792
    s_nop 0
    buffer_load_dwordx4 v25, s[8:11], s51 offen lds
    s_add_u32 m0, s50, 34816
    s_nop 0
    buffer_load_dwordx4 v26, s[8:11], s51 offen lds
    s_add_u32 m0, s50, 35840
    s_nop 0
    buffer_load_dwordx4 v27, s[8:11], s51 offen lds
    s_add_u32 m0, s50, 49152
    s_nop 0
    buffer_load_dwordx4 v28, s[12:15], s51 offen lds
    s_add_u32 m0, s50, 50176
    s_nop 0
    buffer_load_dwordx4 v29, s[12:15], s51 offen lds
    s_add_u32 m0, s50, 51200
    s_nop 0
    buffer_load_dwordx4 v30, s[12:15], s51 offen lds
    s_add_u32 m0, s50, 52224
    s_nop 0
    buffer_load_dwordx4 v31, s[12:15], s51 offen lds
    s_waitcnt vmcnt(8)
    s_barrier
    s_cmp_le_u32 s62, 2
    s_addc_u32 s51, s63, 2
    s_cmp_ge_u32 s51, 9
    s_cselect_b32 s52, 9, 0
    s_sub_u32 s51, s51, s52
    s_lshl_b32 s51, s51, 7
    s_add_u32 m0, s50, 65536
    s_nop 0
    buffer_load_dwordx4 v24, s[8:11], s51 offen lds
    s_add_u32 m0, s50, 66560
    s_nop 0
    buffer_load_dwordx4 v25, s[8:11], s51 offen lds
    s_add_u32 m0, s50, 67584
    s_nop 0
    buffer_load_dwordx4 v26, s[8:11], s51 offen lds
    s_add_u32 m0, s50, 68608
    s_nop 0
    buffer_load_dwordx4 v27, s[8:11], s51 offen lds
    s_add_u32 m0, s50, 81920
    s_nop 0
    buffer_load_dwordx4 v28, s[12:15], s51 offen lds
    s_add_u32 m0, s50, 82944
    s_nop 0
    buffer_load_dwordx4 v29, s[12:15], s51 offen lds
    s_add_u32 m0, s50, 83968
    s_nop 0
    buffer_load_dwordx4 v30, s[12:15], s51 offen lds
    s_add_u32 m0, s50, 84992
    s_nop 0
    buffer_load_dwordx4 v31, s[12:15], s51 offen lds
    s_waitcnt vmcnt(8)
    s_barrier
    s_cmp_le_u32 s62, 3
    s_addc_u32 s51, s63, 3
    s_cmp_ge_u32 s51, 9
    s_cselect_b32 s52, 9, 0
    s_sub_u32 s51, s51, s52
    s_lshl_b32 s51, s51, 7
    s_add_u32 m0, s50, 98304
    s_nop 0
    buffer_load_dwordx4 v24, s[8:11], s51 offen lds
    s_add_u32 m0, s50, 99328
    s_nop 0
    buffer_load_dwordx4 v25, s[8:11], s51 offen lds
    s_add_u32 m0, s50, 100352
    s_nop 0
    buffer_load_dwordx4 v26, s[8:11], s51 offen lds
    s_add_u32 m0, s50, 101376
    s_nop 0
    buffer_load_dwordx4 v27, s[8:11], s51 offen lds
    s_add_u32 m0, s50, 114688
    s_nop 0
    buffer_load_dwordx4 v28, s[12:15], s51 offen lds
    s_add_u32 m0, s50, 115712
    s_nop 0
    buffer_load_dwordx4 v29, s[12:15], s51 offen lds
    s_add_u32 m0, s50, 116736
    s_nop 0
    buffer_load_dwordx4 v30, s[12:15], s51 offen lds
    s_add_u32 m0, s50, 117760
    s_nop 0
    buffer_load_dwordx4 v31, s[12:15], s51 offen lds
    s_waitcnt vmcnt(8)
    s_barrier
    s_cmp_le_u32 s62, 4
    s_addc_u32 s51, s63, 4
    s_cmp_ge_u32 s51, 9
    s_cselect_b32 s52, 9, 0
    s_sub_u32 s51, s51, s52
    s_lshl_b32 s51, s51, 7
    s_add_u32 m0, s50, 0
    s_nop 0
    buffer_load_dwordx4 v24, s[8:11], s51 offen lds
    s_add_u32 m0, s50, 1024
    s_nop 0
    buffer_load_dwordx4 v25, s[8:11], s51 offen lds
    s_add_u32 m0, s50, 2048
    s_nop 0
    buffer_load_dwordx4 v26, s[8:11], s51 offen lds
    s_add_u32 m0, s50, 3072
    s_nop 0
    buffer_load_dwordx4 v27, s[8:11], s51 offen lds
    s_add_u32 m0, s50, 16384
    s_nop 0
    buffer_load_dwordx4 v28, s[12:15], s51 offen lds
    s_add_u32 m0, s50, 17408
    s_nop 0
    buffer_load_dwordx4 v29, s[12:15], s51 offen lds
    s_add_u32 m0, s50, 18432
    s_nop 0
    buffer_load_dwordx4 v30, s[12:15], s51 offen lds
    s_add_u32 m0, s50, 19456
    s_nop 0
    buffer_load_dwordx4 v31, s[12:15], s51 offen lds
    s_waitcnt vmcnt(8)
    s_barrier
    s_cmp_le_u32 s62, 5
    s_addc_u32 s51, s63, 5
    s_cmp_ge_u32 s51, 9
    s_cselect_b32 s52, 9, 0
    s_sub_u32 s51, s51, s52
    s_lshl_b32 s51, s51, 7
    s_add_u32 m0, s50, 32768
    s_nop 0
    buffer_load_dwordx4 v24, s[8:11], s51 offen lds
    s_add_u32 m0, s50, 33792
    s_nop 0
    buffer_load_dwordx4 v25, s[8:11], s51 offen lds
    s_add_u32 m0, s50, 34816
    s_nop 0
    buffer_load_dwordx4 v26, s[8:11], s51 offen lds
    s_add_u32 m0, s50, 35840
    s_nop 0
    buffer_load_dwordx4 v27, s[8:11], s51 offen lds
    s_add_u32 m0, s50, 49152
    s_nop 0
    buffer_load_dwordx4 v28, s[12:15], s51 offen lds
    s_add_u32 m0, s50, 50176
    s_nop 0
    buffer_load_dwordx4 v29, s[12:15], s51 offen lds
    s_add_u32 m0, s50, 51200
    s_nop 0
    buffer_load_dwordx4 v30, s[12:15], s51 offen lds
    s_add_u32 m0, s50, 52224
    s_nop 0
    buffer_load_dwordx4 v31, s[12:15], s51 offen lds
    s_waitcnt vmcnt(8)
    s_barrier
    s_cmp_le_u32 s62, 6
    s_addc_u32 s51, s63, 6
    s_cmp_ge_u32 s51, 9
    s_cselect_b32 s52, 9, 0
    s_sub_u32 s51, s51, s52
    s_lshl_b32 s51, s51, 7
    s_add_u32 m0, s50, 65536
    s_nop 0
    buffer_load_dwordx4 v24, s[8:11], s51 offen lds
    s_add_u32 m0, s50, 66560
    s_nop 0
    buffer_load_dwordx4 v25, s[8:11], s51 offen lds
    s_add_u32 m0, s50, 67584
    s_nop 0
    buffer_load_dwordx4 v26, s[8:11], s51 offen lds
    s_add_u32 m0, s50, 68608
    s_nop 0
    buffer_load_dwordx4 v27, s[8:11], s51 offen lds
    s_add_u32 m0, s50, 81920
    s_nop 0
    buffer_load_dwordx4 v28, s[12:15], s51 offen lds
    s_add_u32 m0, s50, 82944
    s_nop 0
    buffer_load_dwordx4 v29, s[12:15], s51 offen lds
    s_add_u32 m0, s50, 83968
    s_nop 0
    buffer_load_dwordx4 v30, s[12:15], s51 offen lds
    s_add_u32 m0, s50, 84992
    s_nop 0
    buffer_load_dwordx4 v31, s[12:15], s51 offen lds
    s_waitcnt vmcnt(8)
    s_barrier
    s_cmp_le_u32 s62, 7
    s_addc_u32 s51, s63, 7
    s_cmp_ge_u32 s51, 9
    s_cselect_b32 s52, 9, 0
    s_sub_u32 s51, s51, s52
    s_lshl_b32 s51, s51, 7
    s_add_u32 m0, s50, 98304
    s_nop 0
    buffer_load_dwordx4 v24, s[8:11], s51 offen lds
    s_add_u32 m0, s50, 99328
    s_nop 0
    buffer_load_dwordx4 v25, s[8:11], s51 offen lds
    s_add_u32 m0, s50, 100352
    s_nop 0
    buffer_load_dwordx4 v26, s[8:11], s51 offen lds
    s_add_u32 m0, s50, 101376
    s_nop 0
    buffer_load_dwordx4 v27, s[8:11], s51 offen lds
    s_add_u32 m0, s50, 114688
    s_nop 0
    buffer_load_dwordx4 v28, s[12:15], s51 offen lds
    s_add_u32 m0, s50, 115712
    s_nop 0
    buffer_load_dwordx4 v29, s[12:15], s51 offen lds
    s_add_u32 m0, s50, 116736
    s_nop 0
    buffer_load_dwordx4 v30, s[12:15], s51 offen lds
    s_add_u32 m0, s50, 117760
    s_nop 0
    buffer_load_dwordx4 v31, s[12:15], s51 offen lds
    s_waitcnt vmcnt(8)
    s_barrier
    s_lshl_b32 s51, s5, 7
    s_add_u32 m0, s50, 0
    s_nop 0
    buffer_load_dwordx4 v24, s[8:11], s51 offen lds
    s_add_u32 m0, s50, 1024
    s_nop 0
    buffer_load_dwordx4 v25, s[8:11], s51 offen lds
    s_add_u32 m0, s50, 2048
    s_nop 0
    buffer_load_dwordx4 v26, s[8:11], s51 offen lds
    s_add_u32 m0, s50, 3072
    s_nop 0
    buffer_load_dwordx4 v27, s[8:11], s51 offen lds
    s_add_u32 m0, s50, 16384
    s_nop 0
    buffer_load_dwordx4 v28, s[12:15], s51 offen lds
    s_add_u32 m0, s50, 17408
    s_nop 0
    buffer_load_dwordx4 v29, s[12:15], s51 offen lds
    s_add_u32 m0, s50, 18432
    s_nop 0
    buffer_load_dwordx4 v30, s[12:15], s51 offen lds
    s_add_u32 m0, s50, 19456
    s_nop 0
    buffer_load_dwordx4 v31, s[12:15], s51 offen lds
    s_cmp_ge_u32 s44, 2
    s_cselect_b32 s48, s34, s32
    s_cselect_b32 s49, s35, s33
    s_mov_b32 s12, s48
    s_and_b32 s13, s49, 0xffff
    s_mov_b32 s14, 0xa2000
    s_mov_b32 s15, 0x00020000
    s_waitcnt vmcnt(8)
    s_barrier
    s_add_u32 s51, s5, 2
    s_add_u32 s61, s50, 32768
    s_cmp_ge_u32 s51, 9
    s_cselect_b32 s52, 9, 0
    s_sub_u32 s51, s51, s52
    s_lshl_b32 s51, s51, 7
    s_add_u32 m0, s61, 0
    s_nop 0
    buffer_load_dwordx4 v28, s[12:15], s51 offen lds
    s_add_u32 m0, s61, 1024
    s_nop 0
    buffer_load_dwordx4 v29, s[12:15], s51 offen lds
    s_add_u32 m0, s61, 2048
    s_nop 0
    buffer_load_dwordx4 v30, s[12:15], s51 offen lds
    s_add_u32 m0, s61, 3072
    s_nop 0
    buffer_load_dwordx4 v31, s[12:15], s51 offen lds
    s_add_u32 s51, s5, 3
    s_add_u32 s61, s50, 49152
    s_cmp_ge_u32 s51, 9
    s_cselect_b32 s52, 9, 0
    s_sub_u32 s51, s51, s52
    s_lshl_b32 s51, s51, 7
    s_add_u32 m0, s61, 0
    s_nop 0
    buffer_load_dwordx4 v28, s[12:15], s51 offen lds
    s_add_u32 m0, s61, 1024
    s_nop 0
    buffer_load_dwordx4 v29, s[12:15], s51 offen lds
    s_add_u32 m0, s61, 2048
    s_nop 0
    buffer_load_dwordx4 v30, s[12:15], s51 offen lds
    s_add_u32 m0, s61, 3072
    s_nop 0
    buffer_load_dwordx4 v31, s[12:15], s51 offen lds
    s_waitcnt vmcnt(8)
    s_barrier
    ds_read_b128 v[48:51], v21
    v_xor_b32 v21, 32, v21
    ds_read_b128 v[52:55], v21
    v_add_u32 v18, 1, v18
    s_waitcnt lgkmcnt(0)
    s_barrier
    s_mul_i32 s60, s4, 65
    s_lshr_b32 s60, s60, 8
    s_mul_i32 s60, s60, 4
    s_sub_u32 s60, s4, s60
    s_mov_b32 s64, 0x4105
    s_add_u32 s61, s60, 0
    s_cmp_ge_u32 s61, 4
    s_cselect_b32 s52, 4, 0
    s_sub_u32 s61, s61, s52
    s_lshl_b32 s61, s61, 2
    s_lshr_b32 s61, s64, s61
    s_and_b32 s61, s61, 15
    s_add_u32 s51, s5, s61
    s_cmp_ge_u32 s61, 6
    s_addc_u32 s61, s61, 0
    s_lshl_b32 s61, s61, 14
    s_add_u32 s61, s61, s50
    s_cmp_ge_u32 s51, 9
    s_cselect_b32 s52, 9, 0
    s_sub_u32 s51, s51, s52
    s_lshl_b32 s51, s51, 7
    s_add_u32 m0, s61, 0
    s_nop 0
    buffer_load_dwordx4 v28, s[12:15], s51 offen lds
    s_add_u32 m0, s61, 1024
    s_nop 0
    buffer_load_dwordx4 v29, s[12:15], s51 offen lds
    s_add_u32 m0, s61, 2048
    s_nop 0
    buffer_load_dwordx4 v30, s[12:15], s51 offen lds
    s_add_u32 m0, s61, 3072
    s_nop 0
    buffer_load_dwordx4 v31, s[12:15], s51 offen lds
    s_add_u32 s61, s60, 1
    s_cmp_ge_u32 s61, 4
    s_cselect_b32 s52, 4, 0
    s_sub_u32 s61, s61, s52
    s_lshl_b32 s61, s61, 2
    s_lshr_b32 s61, s64, s61
    s_and_b32 s61, s61, 15
    s_add_u32 s51, s5, s61
    s_cmp_ge_u32 s61, 6
    s_addc_u32 s61, s61, 0
    s_lshl_b32 s61, s61, 14
    s_add_u32 s61, s61, s50
    s_cmp_ge_u32 s51, 9
    s_cselect_b32 s52, 9, 0
    s_sub_u32 s51, s51, s52
    s_lshl_b32 s51, s51, 7
    s_add_u32 m0, s61, 0
    s_nop 0
    buffer_load_dwordx4 v28, s[12:15], s51 offen lds
    s_add_u32 m0, s61, 1024
    s_nop 0
    buffer_load_dwordx4 v29, s[12:15], s51 offen lds
    s_add_u32 m0, s61, 2048
    s_nop 0
    buffer_load_dwordx4 v30, s[12:15], s51 offen lds
    s_add_u32 m0, s61, 3072
    s_nop 0
    buffer_load_dwordx4 v31, s[12:15], s51 offen lds
    s_add_u32 s61, s60, 2
    s_cmp_ge_u32 s61, 4
    s_cselect_b32 s52, 4, 0
    s_sub_u32 s61, s61, s52
    s_lshl_b32 s61, s61, 2
    s_lshr_b32 s61, s64, s61
    s_and_b32 s61, s61, 15
    s_add_u32 s51, s5, s61
    s_cmp_ge_u32 s61, 6
    s_addc_u32 s61, s61, 0
    s_lshl_b32 s61, s61, 14
    s_add_u32 s61, s61, s50
    s_cmp_ge_u32 s51, 9
    s_cselect_b32 s52, 9, 0
    s_sub_u32 s51, s51, s52
    s_lshl_b32 s51, s51, 7
    s_add_u32 m0, s61, 0
    s_nop 0
    buffer_load_dwordx4 v28, s[12:15], s51 offen lds
    s_add_u32 m0, s61, 1024
    s_nop 0
    buffer_load_dwordx4 v29, s[12:15], s51 offen lds
    s_add_u32 m0, s61, 2048
    s_nop 0
    buffer_load_dwordx4 v30, s[12:15], s51 offen lds
    s_add_u32 m0, s61, 3072
    s_nop 0
    buffer_load_dwordx4 v31, s[12:15], s51 offen lds
    s_add_u32 s61, s60, 3
    s_cmp_ge_u32 s61, 4
    s_cselect_b32 s52, 4, 0
    s_sub_u32 s61, s61, s52
    s_lshl_b32 s61, s61, 2
    s_lshr_b32 s61, s64, s61
    s_and_b32 s61, s61, 15
    s_add_u32 s51, s5, s61
    s_cmp_ge_u32 s61, 6
    s_addc_u32 s61, s61, 0
    s_lshl_b32 s61, s61, 14
    s_add_u32 s61, s61, s50
    s_cmp_ge_u32 s51, 9
    s_cselect_b32 s52, 9, 0
    s_sub_u32 s51, s51, s52
    s_lshl_b32 s51, s51, 7
    s_add_u32 m0, s61, 0
    s_nop 0
    buffer_load_dwordx4 v28, s[12:15], s51 offen lds
    s_add_u32 m0, s61, 1024
    s_nop 0
    buffer_load_dwordx4 v29, s[12:15], s51 offen lds
    s_add_u32 m0, s61, 2048
    s_nop 0
    buffer_load_dwordx4 v30, s[12:15], s51 offen lds
    s_add_u32 m0, s61, 3072
    s_nop 0
    buffer_load_dwordx4 v31, s[12:15], s51 offen lds
    v_and_b32 v2, 1, v1
    v_lshlrev_b32 v2, 4, v2
    v_lshlrev_b32 v20, v2, v20
    v_bfe_u32 v2, v1, 1, 4
    v_lshrrev_b32 v56, 5, v1
    v_lshlrev_b32 v56, 2, v56
    v_sub_u32 v2, v2, v56
    v_cmp_eq_u32 vcc, 0, v2
    s_nop 1
    v_cndmask_b32 v56, 0, v20, vcc
    v_cmp_eq_u32 vcc, 1, v2
    s_nop 1
    v_cndmask_b32 v57, 0, v20, vcc
    v_cmp_eq_u32 vcc, 2, v2
    s_nop 1
    v_cndmask_b32 v58, 0, v20, vcc
    v_cmp_eq_u32 vcc, 3, v2
    s_nop 1
    v_cndmask_b32 v59, 0, v20, vcc
    v_cmp_eq_u32 vcc, 8, v2
    s_nop 1
    v_cndmask_b32 v60, 0, v20, vcc
    v_cmp_eq_u32 vcc, 9, v2
    s_nop 1
    v_cndmask_b32 v61, 0, v20, vcc
    v_cmp_eq_u32 vcc, 10, v2
    s_nop 1
    v_cndmask_b32 v62, 0, v20, vcc
    v_cmp_eq_u32 vcc, 11, v2
    s_nop 1
    v_cndmask_b32 v63, 0, v20, vcc
    v_mfma_f32_32x32x16_bf16 v[32:47], v[48:51], v[56:59], 0
    s_nop 0
    v_mfma_f32_32x32x16_bf16 v[32:47], v[52:55], v[60:63], v[32:47]
    v_and_b32 v64, 31, v1
    v_lshrrev_b32 v65, 5, v1
    v_bfe_u32 v66, v64, 1, 3
    v_xor_b32 v66, v66, v65
    v_lshlrev_b32 v64, 7, v64
    s_lshr_b32 s76, s3, 2
    s_lshl_b32 s76, s76, 12
    v_add_u32 v64, s76, v64
    v_xor_b32 v67, 0, v66
    v_lshl_add_u32 v10, v67, 4, v64
    v_xor_b32 v67, 2, v66
    v_lshl_add_u32 v11, v67, 4, v64
    v_xor_b32 v67, 4, v66
    v_lshl_add_u32 v12, v67, 4, v64
    v_xor_b32 v67, 6, v66
    v_lshl_add_u32 v13, v67, 4, v64
    v_bfe_u32 v64, v1, 4, 1
    v_bfe_u32 v66, v1, 1, 1
    v_lshl_add_u32 v64, v64, 1, v66
    v_bfe_u32 v66, v1, 2, 2
    v_lshl_add_u32 v66, v65, 3, v66
    v_lshlrev_b32 v67, 2, v64
    v_xor_b32 v66, v66, v67
    v_lshlrev_b32 v66, 4, v66
    v_lshl_add_u32 v66, v64, 11, v66
    v_and_b32 v67, 1, v1
    v_lshl_add_u32 v66, v67, 3, v66
    s_and_b32 s76, s3, 3
    s_lshl_b32 s76, s76, 8
    v_add_u32 v8, s76, v66
    v_xor_b32 v9, 64, v8
    s_lshr_b32 s76, s3, 1
    s_lshl_b32 s76, s76, 2
    v_xor_b32 v66, s76, v1
    v_lshlrev_b32 v14, 4, v66
    s_lshl_b32 s56, s3, 10
    s_mul_i32 s58, s4, 294912
    s_add_u32 s58, s58, 1048576
    s_add_u32 s58, s58, s56
    s_lshl_b32 s59, s5, 15
    s_add_u32 s59, s59, s58
    s_add_u32 s80, s58, 294912
    v_min_u32 v16, 35, v1
    v_lshlrev_b32 v16, 2, v16
    s_lshl_b32 s81, s4, 8
    s_add_u32 s81, s81, 1024
    s_mov_b32 s24, s40
    s_and_b32 s25, s41, 0xffff
    s_mov_b32 s26, 0x900000
    s_mov_b32 s27, 0x00020000
    s_waitcnt vmcnt(0)
    s_barrier
    s_add_u32 s51, s5, 6
    s_add_u32 s61, s50, 114688
    s_cmp_ge_u32 s51, 9
    s_cselect_b32 s52, 9, 0
    s_sub_u32 s51, s51, s52
    s_lshl_b32 s51, s51, 7
    s_add_u32 m0, s61, 0
    s_nop 0
    buffer_load_dwordx4 v28, s[12:15], s51 offen lds
    s_add_u32 m0, s61, 1024
    s_nop 0
    buffer_load_dwordx4 v29, s[12:15], s51 offen lds
    s_add_u32 m0, s61, 2048
    s_nop 0
    buffer_load_dwordx4 v30, s[12:15], s51 offen lds
    s_add_u32 m0, s61, 3072
    s_nop 0
    buffer_load_dwordx4 v31, s[12:15], s51 offen lds
    s_add_u32 s51, s5, 7
    s_add_u32 s61, s50, 131072
    s_cmp_ge_u32 s51, 9
    s_cselect_b32 s52, 9, 0
    s_sub_u32 s51, s51, s52
    s_lshl_b32 s51, s51, 7
    s_add_u32 m0, s61, 0
    s_nop 0
    buffer_load_dwordx4 v28, s[12:15], s51 offen lds
    s_add_u32 m0, s61, 1024
    s_nop 0
    buffer_load_dwordx4 v29, s[12:15], s51 offen lds
    s_add_u32 m0, s61, 2048
    s_nop 0
    buffer_load_dwordx4 v30, s[12:15], s51 offen lds
    s_add_u32 m0, s61, 3072
    s_nop 0
    buffer_load_dwordx4 v31, s[12:15], s51 offen lds
    s_add_u32 s51, s5, 8
    s_add_u32 s61, s50, 147456
    s_cmp_ge_u32 s51, 9
    s_cselect_b32 s52, 9, 0
    s_sub_u32 s51, s51, s52
    s_lshl_b32 s51, s51, 7
    s_add_u32 m0, s61, 0
    s_nop 0
    buffer_load_dwordx4 v28, s[12:15], s51 offen lds
    s_add_u32 m0, s61, 1024
    s_nop 0
    buffer_load_dwordx4 v29, s[12:15], s51 offen lds
    s_add_u32 m0, s61, 2048
    s_nop 0
    buffer_load_dwordx4 v30, s[12:15], s51 offen lds
    s_add_u32 m0, s61, 3072
    s_nop 0
    buffer_load_dwordx4 v31, s[12:15], s51 offen lds
    ds_read_b128 v[64:67], v10 offset:0
    ds_read_b128 v[68:71], v10 offset:8192
    ds_read_b128 v[72:75], v11 offset:0
    ds_read_b128 v[76:79], v11 offset:8192
    ds_read_b128 v[80:83], v12 offset:0
    ds_read_b128 v[84:87], v12 offset:8192
    ds_read_b128 v[88:91], v13 offset:0
    ds_read_b128 v[92:95], v13 offset:8192
    ds_read_b128 v[96:99], v10 offset:16384
    ds_read_b128 v[100:103], v10 offset:24576
    ds_read_b128 v[104:107], v11 offset:16384
    ds_read_b128 v[108:111], v11 offset:24576
    ds_read_b128 v[112:115], v12 offset:16384
    ds_read_b128 v[116:119], v12 offset:24576
    ds_read_b128 v[120:123], v13 offset:16384
    ds_read_b128 v[124:127], v13 offset:24576
    ds_read_b128 v[128:131], v10 offset:32768
    ds_read_b128 v[132:135], v10 offset:40960
    ds_read_b128 v[136:139], v11 offset:32768
    ds_read_b128 v[140:143], v11 offset:40960
    ds_read_b128 v[144:147], v12 offset:32768
    ds_read_b128 v[148:151], v12 offset:40960
    ds_read_b128 v[152:155], v13 offset:32768
    ds_read_b128 v[156:159], v13 offset:40960
    ds_read_b128 v[160:163], v10 offset:49152
    ds_read_b128 v[164:167], v10 offset:57344
    ds_read_b128 v[168:171], v11 offset:49152
    ds_read_b128 v[172:175], v11 offset:57344
    ds_read_b128 v[176:179], v12 offset:49152
    ds_read_b128 v[180:183], v12 offset:57344
    ds_read_b128 v[184:187], v13 offset:49152
    ds_read_b128 v[188:191], v13 offset:57344
    v_add_u32 v10, 0x10000, v10
    v_add_u32 v11, 0x10000, v11
    v_add_u32 v12, 0x10000, v12
    v_add_u32 v13, 0x10000, v13
    ds_read_b128 v[192:195], v10 offset:0
    ds_read_b128 v[196:199], v10 offset:8192
    ds_read_b128 v[200:203], v11 offset:0
    ds_read_b128 v[204:207], v11 offset:8192
    ds_read_b128 v[208:211], v12 offset:0
    ds_read_b128 v[212:215], v12 offset:8192
    ds_read_b128 v[216:219], v13 offset:0
    ds_read_b128 v[220:223], v13 offset:8192
    ds_read_b128 v[224:227], v10 offset:16384
    ds_read_b128 v[228:231], v10 offset:24576
    ds_read_b128 v[232:235], v11 offset:16384
    ds_read_b128 v[236:239], v11 offset:24576
    ds_read_b128 v[240:243], v12 offset:16384
    ds_read_b128 v[244:247], v12 offset:24576
    ds_read_b128 v[248:251], v13 offset:16384
    ds_read_b128 v[252:255], v13 offset:24576
    v_add_u32 v10, 49152, v10
    v_add_u32 v11, 49152, v11
    v_add_u32 v12, 49152, v12
    v_add_u32 v13, 49152, v13
    s_waitcnt lgkmcnt(0)
    s_barrier
    s_add_u32 m0, s56, 32768
    s_nop 0
    buffer_load_dwordx4 v14, s[16:19], s59 offen sc1 lds
    s_add_u32 s59, s59, 8192
    s_add_u32 m0, s56, 40960
    s_nop 0
    buffer_load_dwordx4 v14, s[16:19], s59 offen sc1 lds
    s_add_u32 s59, s59, 8192
    s_add_u32 m0, s56, 49152
    s_nop 0
    buffer_load_dwordx4 v14, s[16:19], s59 offen sc1 lds
    s_add_u32 s59, s59, 8192
    s_add_u32 m0, s56, 57344
    s_nop 0
    buffer_load_dwordx4 v14, s[16:19], s59 offen sc1 lds
    s_add_u32 s59, s59, 8192
    s_cmp_ge_u32 s59, s80
    s_cselect_b32 s59, s58, s59
    s_branch L_g2main
L_bcomp:
    s_waitcnt lgkmcnt(0)
    s_mov_b32 s16, s22
    s_and_b32 s17, s23, 0xffff
    s_mov_b32 s18, 0x10000000
    s_mov_b32 s19, 0x00020000
    v_and_b32 v3, 15, v1
    v_lshrrev_b32 v4, 4, v1
    s_lshl_b32 s44, s5, 6
    s_lshl_b32 s45, s3, 4
    s_add_u32 s44, s44, s45
    v_add_u32 v5, s44, v3
    v_lshlrev_b32 v6, 1, v5
    global_load_ushort v8, v6, s[24:25]
    global_load_ushort v9, v6, s[26:27]
    global_load_ushort v10, v6, s[36:37]
    v_mov_b32 v17, 0
    buffer_load_dword v18, v17, s[16:19], 0 offen sc1
    v_and_b32 v2, 31, v1
    s_lshl_b32 s76, s5, 6
    s_lshr_b32 s77, s3, 2
    s_lshl_b32 s78, s77, 5
    s_add_u32 s76, s76, s78
    v_add_u32 v232, s76, v2
    v_lshlrev_b32 v241, 1, v232
    global_load_ushort v240, v241, s[38:39]
    s_lshl_b32 s76, s4, 7
    s_and_b32 s78, s3, 3
    s_lshl_b32 s79, s78, 5
    s_add_u32 s76, s76, s79
    v_lshrrev_b32 v233, 5, v1
    v_lshl_add_u32 v15, v233, 2, s76
    s_movk_i32 s76, 4608
    v_mul_lo_u32 v15, v15, s76
    v_lshl_add_u32 v15, v232, 2, v15
    v_add_u32 v15, 2304, v15
    v_bfe_u32 v241, v2, 1, 3
    v_lshlrev_b32 v241, 4, v241
    s_lshl_b32 s78, s78, 2
    v_add_u32 v241, s78, v241
    v_and_b32 v232, 1, v2
    v_lshl_add_u32 v241, v232, 1, v241
    v_lshrrev_b32 v232, 4, v2
    v_add_u32 v241, v241, v232
    v_bfe_u32 v232, v241, 1, 3
    s_lshl_b32 s77, s77, 2
    v_add_u32 v233, s77, v233
    v_xor_b32 v232, v232, v233
    v_lshlrev_b32 v232, 4, v232
    v_lshl_add_u32 v241, v241, 7, v232
    v_mov_b32 v242, v15
    s_barrier
    v_lshrrev_b32 v7, 1, v3
    v_xor_b32 v7, v7, v4
    v_lshlrev_b32 v7, 4, v7
    v_lshl_add_u32 v32, v3, 7, v7
    v_xor_b32 v33, 64, v32
    v_add_u32 v34, 0x10000, v32
    v_add_u32 v35, 0x10000, v33
    s_lshl_b32 s45, s3, 11
    v_add_u32 v36, s45, v32
    v_add_u32 v37, s45, v33
    v_add_u32 v38, s45, v34
    v_add_u32 v39, s45, v35
    s_barrier
    ds_read_b128 v[160:163], v36 offset:16384
    ds_read_b128 v[164:167], v36 offset:24576
    ds_read_b128 v[128:131], v32 offset:0
    ds_read_b128 v[132:135], v32 offset:2048
    ds_read_b128 v[136:139], v32 offset:4096
    ds_read_b128 v[140:143], v32 offset:6144
    ds_read_b128 v[144:147], v32 offset:8192
    ds_read_b128 v[148:151], v32 offset:10240
    ds_read_b128 v[152:155], v32 offset:12288
    ds_read_b128 v[156:159], v32 offset:14336
    s_waitcnt lgkmcnt(7)
    v_mfma_f32_16x16x32_bf16 v[64:67], v[128:131], v[160:163], 0
    ds_read_b128 v[200:203], v37 offset:16384
    v_mfma_f32_16x16x32_bf16 v[96:99], v[128:131], v[164:167], 0
    ds_read_b128 v[204:207], v37 offset:24576
    s_waitcnt lgkmcnt(8)
    v_mfma_f32_16x16x32_bf16 v[68:71], v[132:135], v[160:163], 0
    s_waitcnt vmcnt(0)
    v_add_u32 v18, 1, v18
    v_mfma_f32_16x16x32_bf16 v[100:103], v[132:135], v[164:167], 0
    ds_read_b128 v[168:171], v33 offset:0
    s_waitcnt lgkmcnt(8)
    v_mfma_f32_16x16x32_bf16 v[72:75], v[136:139], v[160:163], 0
    ds_read_b128 v[172:175], v33 offset:2048
    v_mfma_f32_16x16x32_bf16 v[104:107], v[136:139], v[164:167], 0
    s_getreg_b32 s54, hwreg(HW_REG_XCC_ID, 0, 4)
    s_lshl_b32 s55, s4, 7
    s_waitcnt lgkmcnt(8)
    v_mfma_f32_16x16x32_bf16 v[76:79], v[140:143], v[160:163], 0
    ds_read_b128 v[176:179], v33 offset:4096
    v_mfma_f32_16x16x32_bf16 v[108:111], v[140:143], v[164:167], 0
    ds_read_b128 v[180:183], v33 offset:6144
    s_waitcnt lgkmcnt(9)
    v_mfma_f32_16x16x32_bf16 v[80:83], v[144:147], v[160:163], 0
    s_add_u32 s55, s55, 6144
    v_mov_b32 v19, s54
    v_mfma_f32_16x16x32_bf16 v[112:115], v[144:147], v[164:167], 0
    ds_read_b128 v[184:187], v33 offset:8192
    s_waitcnt lgkmcnt(9)
    v_mfma_f32_16x16x32_bf16 v[84:87], v[148:151], v[160:163], 0
    ds_read_b128 v[188:191], v33 offset:10240
    v_mfma_f32_16x16x32_bf16 v[116:119], v[148:151], v[164:167], 0
    s_lshl_b32 s56, s5, 3
    s_cmp_eq_u32 s3, 0
    s_waitcnt lgkmcnt(9)
    v_mfma_f32_16x16x32_bf16 v[88:91], v[152:155], v[160:163], 0
    ds_read_b128 v[192:195], v33 offset:12288
    v_mfma_f32_16x16x32_bf16 v[120:123], v[152:155], v[164:167], 0
    ds_read_b128 v[196:199], v33 offset:14336
    s_waitcnt lgkmcnt(10)
    v_mfma_f32_16x16x32_bf16 v[92:95], v[156:159], v[160:163], 0
    s_cselect_b32 s56, s56, -16
    v_mov_b32 v7, s56
    v_mfma_f32_16x16x32_bf16 v[124:127], v[156:159], v[164:167], 0
    v_cmp_eq_u32 vcc, 0, v1
    s_nop 1
    v_cndmask_b32 v7, -16, v7, vcc
    s_barrier
    s_waitcnt lgkmcnt(7)
    v_mfma_f32_16x16x32_bf16 v[64:67], v[168:171], v[200:203], v[64:67]
    ds_read_b128 v[160:163], v36 offset:49152
    v_mfma_f32_16x16x32_bf16 v[96:99], v[168:171], v[204:207], v[96:99]
    ds_read_b128 v[164:167], v36 offset:57344
    s_waitcnt lgkmcnt(8)
    v_mfma_f32_16x16x32_bf16 v[68:71], v[172:175], v[200:203], v[68:71]
    buffer_store_dwordx2 v[18:19], v7, s[16:19], s55 offen sc1
    v_lshlrev_b32 v8, 16, v8
    v_mfma_f32_16x16x32_bf16 v[100:103], v[172:175], v[204:207], v[100:103]
    ds_read_b128 v[128:131], v32 offset:32768
    s_waitcnt lgkmcnt(8)
    v_mfma_f32_16x16x32_bf16 v[72:75], v[176:179], v[200:203], v[72:75]
    ds_read_b128 v[132:135], v32 offset:34816
    v_mfma_f32_16x16x32_bf16 v[104:107], v[176:179], v[204:207], v[104:107]
    v_lshlrev_b32 v9, 16, v9
    v_lshlrev_b32 v10, 16, v10
    s_waitcnt lgkmcnt(8)
    v_mfma_f32_16x16x32_bf16 v[76:79], v[180:183], v[200:203], v[76:79]
    ds_read_b128 v[136:139], v32 offset:36864
    v_mfma_f32_16x16x32_bf16 v[108:111], v[180:183], v[204:207], v[108:111]
    ds_read_b128 v[140:143], v32 offset:38912
    s_waitcnt lgkmcnt(9)
    v_mfma_f32_16x16x32_bf16 v[80:83], v[184:187], v[200:203], v[80:83]
    v_mul_f32 v10, 0x3fb8aa3b, v10
    v_exp_f32 v10, v10
    v_mfma_f32_16x16x32_bf16 v[112:115], v[184:187], v[204:207], v[112:115]
    ds_read_b128 v[144:147], v32 offset:40960
    s_waitcnt lgkmcnt(9)
    v_mfma_f32_16x16x32_bf16 v[84:87], v[188:191], v[200:203], v[84:87]
    ds_read_b128 v[148:151], v32 offset:43008
    v_mfma_f32_16x16x32_bf16 v[116:119], v[188:191], v[204:207], v[116:119]
    v_cvt_pk_bf16_f32 v10, v10, v10
    v_and_b32 v10, 0xffff0000, v10
    s_waitcnt lgkmcnt(9)
    v_mfma_f32_16x16x32_bf16 v[88:91], v[192:195], v[200:203], v[88:91]
    ds_read_b128 v[152:155], v32 offset:45056
    v_mfma_f32_16x16x32_bf16 v[120:123], v[192:195], v[204:207], v[120:123]
    ds_read_b128 v[156:159], v32 offset:47104
    s_waitcnt lgkmcnt(10)
    v_mfma_f32_16x16x32_bf16 v[92:95], v[196:199], v[200:203], v[92:95]
    v_mul_f32 v11, v10, v8
    v_mul_f32 v12, v10, v9
    v_mfma_f32_16x16x32_bf16 v[124:127], v[196:199], v[204:207], v[124:127]
    v_mul_f32 v11, 0x3fb8aa3b, v11
    v_mul_f32 v12, 0x3e22f983, v12
    s_waitcnt lgkmcnt(7)
    v_mfma_f32_16x16x32_bf16 v[64:67], v[128:131], v[160:163], v[64:67]
    ds_read_b128 v[200:203], v37 offset:49152
    v_mfma_f32_16x16x32_bf16 v[96:99], v[128:131], v[164:167], v[96:99]
    ds_read_b128 v[204:207], v37 offset:57344
    s_waitcnt lgkmcnt(8)
    v_mfma_f32_16x16x32_bf16 v[68:71], v[132:135], v[160:163], v[68:71]
    v_exp_f32 v13, v11
    v_fract_f32 v14, v12
    v_mfma_f32_16x16x32_bf16 v[100:103], v[132:135], v[164:167], v[100:103]
    ds_read_b128 v[168:171], v33 offset:32768
    s_waitcnt lgkmcnt(8)
    v_mfma_f32_16x16x32_bf16 v[72:75], v[136:139], v[160:163], v[72:75]
    ds_read_b128 v[172:175], v33 offset:34816
    v_mfma_f32_16x16x32_bf16 v[104:107], v[136:139], v[164:167], v[104:107]
    v_cos_f32 v20, v14
    v_sin_f32 v21, v14
    s_waitcnt lgkmcnt(8)
    v_mfma_f32_16x16x32_bf16 v[76:79], v[140:143], v[160:163], v[76:79]
    ds_read_b128 v[176:179], v33 offset:36864
    v_mfma_f32_16x16x32_bf16 v[108:111], v[140:143], v[164:167], v[108:111]
    ds_read_b128 v[180:183], v33 offset:38912
    s_waitcnt lgkmcnt(9)
    v_mfma_f32_16x16x32_bf16 v[80:83], v[144:147], v[160:163], v[80:83]
    v_mul_f32 v20, v13, v20
    v_mul_f32 v21, v13, v21
    v_mfma_f32_16x16x32_bf16 v[112:115], v[144:147], v[164:167], v[112:115]
    ds_read_b128 v[184:187], v33 offset:40960
    s_waitcnt lgkmcnt(9)
    v_mfma_f32_16x16x32_bf16 v[84:87], v[148:151], v[160:163], v[84:87]
    ds_read_b128 v[188:191], v33 offset:43008
    v_mfma_f32_16x16x32_bf16 v[116:119], v[148:151], v[164:167], v[116:119]
    v_mul_f32 v13, 0x41800000, v11
    v_mul_f32 v14, 0x41800000, v12
    s_waitcnt lgkmcnt(9)
    v_mfma_f32_16x16x32_bf16 v[88:91], v[152:155], v[160:163], v[88:91]
    ds_read_b128 v[192:195], v33 offset:45056
    v_mfma_f32_16x16x32_bf16 v[120:123], v[152:155], v[164:167], v[120:123]
    ds_read_b128 v[196:199], v33 offset:47104
    s_waitcnt lgkmcnt(10)
    v_mfma_f32_16x16x32_bf16 v[92:95], v[156:159], v[160:163], v[92:95]
    v_exp_f32 v13, v13
    v_fract_f32 v14, v14
    v_mfma_f32_16x16x32_bf16 v[124:127], v[156:159], v[164:167], v[124:127]
    v_cos_f32 v24, v14
    v_sin_f32 v25, v14
    s_barrier
    s_waitcnt lgkmcnt(7)
    v_mfma_f32_16x16x32_bf16 v[64:67], v[168:171], v[200:203], v[64:67]
    ds_read_b128 v[160:163], v38 offset:16384
    v_mfma_f32_16x16x32_bf16 v[96:99], v[168:171], v[204:207], v[96:99]
    ds_read_b128 v[164:167], v38 offset:24576
    s_waitcnt lgkmcnt(8)
    v_mfma_f32_16x16x32_bf16 v[68:71], v[172:175], v[200:203], v[68:71]
    v_mul_f32 v24, v13, v24
    v_mul_f32 v25, v13, v25
    v_mfma_f32_16x16x32_bf16 v[100:103], v[172:175], v[204:207], v[100:103]
    ds_read_b128 v[128:131], v34 offset:0
    s_waitcnt lgkmcnt(8)
    v_mfma_f32_16x16x32_bf16 v[72:75], v[176:179], v[200:203], v[72:75]
    ds_read_b128 v[132:135], v34 offset:2048
    v_mfma_f32_16x16x32_bf16 v[104:107], v[176:179], v[204:207], v[104:107]
    v_mul_f32 v13, 0x42000000, v11
    v_mul_f32 v14, 0x42000000, v12
    s_waitcnt lgkmcnt(8)
    v_mfma_f32_16x16x32_bf16 v[76:79], v[180:183], v[200:203], v[76:79]
    ds_read_b128 v[136:139], v34 offset:4096
    v_mfma_f32_16x16x32_bf16 v[108:111], v[180:183], v[204:207], v[108:111]
    ds_read_b128 v[140:143], v34 offset:6144
    s_waitcnt lgkmcnt(9)
    v_mfma_f32_16x16x32_bf16 v[80:83], v[184:187], v[200:203], v[80:83]
    v_exp_f32 v13, v13
    v_fract_f32 v14, v14
    v_mfma_f32_16x16x32_bf16 v[112:115], v[184:187], v[204:207], v[112:115]
    ds_read_b128 v[144:147], v34 offset:8192
    s_waitcnt lgkmcnt(9)
    v_mfma_f32_16x16x32_bf16 v[84:87], v[188:191], v[200:203], v[84:87]
    ds_read_b128 v[148:151], v34 offset:10240
    v_mfma_f32_16x16x32_bf16 v[116:119], v[188:191], v[204:207], v[116:119]
    v_cos_f32 v26, v14
    v_sin_f32 v27, v14
    s_waitcnt lgkmcnt(9)
    v_mfma_f32_16x16x32_bf16 v[88:91], v[192:195], v[200:203], v[88:91]
    ds_read_b128 v[152:155], v34 offset:12288
    v_mfma_f32_16x16x32_bf16 v[120:123], v[192:195], v[204:207], v[120:123]
    ds_read_b128 v[156:159], v34 offset:14336
    s_waitcnt lgkmcnt(10)
    v_mfma_f32_16x16x32_bf16 v[92:95], v[196:199], v[200:203], v[92:95]
    v_mul_f32 v26, v13, v26
    v_mul_f32 v27, v13, v27
    v_mfma_f32_16x16x32_bf16 v[124:127], v[196:199], v[204:207], v[124:127]
    v_mul_f32 v13, 0x44000000, v11
    v_mul_f32 v14, 0x44000000, v12
    s_waitcnt lgkmcnt(7)
    v_mfma_f32_16x16x32_bf16 v[64:67], v[128:131], v[160:163], v[64:67]
    ds_read_b128 v[200:203], v39 offset:16384
    v_mfma_f32_16x16x32_bf16 v[96:99], v[128:131], v[164:167], v[96:99]
    ds_read_b128 v[204:207], v39 offset:24576
    s_waitcnt lgkmcnt(8)
    v_mfma_f32_16x16x32_bf16 v[68:71], v[132:135], v[160:163], v[68:71]
    v_exp_f32 v13, v13
    v_fract_f32 v14, v14
    v_mfma_f32_16x16x32_bf16 v[100:103], v[132:135], v[164:167], v[100:103]
    ds_read_b128 v[168:171], v35 offset:0
    s_waitcnt lgkmcnt(8)
    v_mfma_f32_16x16x32_bf16 v[72:75], v[136:139], v[160:163], v[72:75]
    ds_read_b128 v[172:175], v35 offset:2048
    v_mfma_f32_16x16x32_bf16 v[104:107], v[136:139], v[164:167], v[104:107]
    v_cos_f32 v28, v14
    v_sin_f32 v29, v14
    s_waitcnt lgkmcnt(8)
    v_mfma_f32_16x16x32_bf16 v[76:79], v[140:143], v[160:163], v[76:79]
    ds_read_b128 v[176:179], v35 offset:4096
    v_mfma_f32_16x16x32_bf16 v[108:111], v[140:143], v[164:167], v[108:111]
    ds_read_b128 v[180:183], v35 offset:6144
    s_waitcnt lgkmcnt(9)
    v_mfma_f32_16x16x32_bf16 v[80:83], v[144:147], v[160:163], v[80:83]
    v_mul_f32 v28, v13, v28
    v_mul_f32 v29, v13, v29
    v_mfma_f32_16x16x32_bf16 v[112:115], v[144:147], v[164:167], v[112:115]
    ds_read_b128 v[184:187], v35 offset:8192
    s_waitcnt lgkmcnt(9)
    v_mfma_f32_16x16x32_bf16 v[84:87], v[148:151], v[160:163], v[84:87]
    ds_read_b128 v[188:191], v35 offset:10240
    v_mfma_f32_16x16x32_bf16 v[116:119], v[148:151], v[164:167], v[116:119]
    v_lshlrev_b32 v15, 5, v4
    v_cvt_f32_u32 v15, v15
    s_waitcnt lgkmcnt(9)
    v_mfma_f32_16x16x32_bf16 v[88:91], v[152:155], v[160:163], v[88:91]
    ds_read_b128 v[192:195], v35 offset:12288
    v_mfma_f32_16x16x32_bf16 v[120:123], v[152:155], v[164:167], v[120:123]
    ds_read_b128 v[196:199], v35 offset:14336
    s_waitcnt lgkmcnt(10)
    v_mfma_f32_16x16x32_bf16 v[92:95], v[156:159], v[160:163], v[92:95]
    v_mul_f32 v13, v15, v11
    v_mul_f32 v14, v15, v12
    v_mfma_f32_16x16x32_bf16 v[124:127], v[156:159], v[164:167], v[124:127]
    v_exp_f32 v13, v13
    v_fract_f32 v14, v14
    s_barrier
    s_waitcnt lgkmcnt(7)
    v_mfma_f32_16x16x32_bf16 v[64:67], v[168:171], v[200:203], v[64:67]
    ds_read_b128 v[160:163], v38 offset:49152
    v_mfma_f32_16x16x32_bf16 v[96:99], v[168:171], v[204:207], v[96:99]
    ds_read_b128 v[164:167], v38 offset:57344
    s_waitcnt lgkmcnt(8)
    v_mfma_f32_16x16x32_bf16 v[68:71], v[172:175], v[200:203], v[68:71]
    v_cos_f32 v30, v14
    v_sin_f32 v31, v14
    v_mfma_f32_16x16x32_bf16 v[100:103], v[172:175], v[204:207], v[100:103]
    ds_read_b128 v[128:131], v34 offset:32768
    s_waitcnt lgkmcnt(8)
    v_mfma_f32_16x16x32_bf16 v[72:75], v[176:179], v[200:203], v[72:75]
    ds_read_b128 v[132:135], v34 offset:34816
    v_mfma_f32_16x16x32_bf16 v[104:107], v[176:179], v[204:207], v[104:107]
    v_mul_f32 v30, v13, v30
    v_mul_f32 v31, v13, v31
    s_waitcnt lgkmcnt(8)
    v_mfma_f32_16x16x32_bf16 v[76:79], v[180:183], v[200:203], v[76:79]
    ds_read_b128 v[136:139], v34 offset:36864
    v_mfma_f32_16x16x32_bf16 v[108:111], v[180:183], v[204:207], v[108:111]
    ds_read_b128 v[140:143], v34 offset:38912
    s_waitcnt lgkmcnt(9)
    v_mfma_f32_16x16x32_bf16 v[80:83], v[184:187], v[200:203], v[80:83]
    v_mul_f32 v15, 4.0, v15
    v_mul_f32 v13, v15, v11
    v_mfma_f32_16x16x32_bf16 v[112:115], v[184:187], v[204:207], v[112:115]
    ds_read_b128 v[144:147], v34 offset:40960
    s_waitcnt lgkmcnt(9)
    v_mfma_f32_16x16x32_bf16 v[84:87], v[188:191], v[200:203], v[84:87]
    ds_read_b128 v[148:151], v34 offset:43008
    v_mfma_f32_16x16x32_bf16 v[116:119], v[188:191], v[204:207], v[116:119]
    v_mul_f32 v14, v15, v12
    v_exp_f32 v13, v13
    s_waitcnt lgkmcnt(9)
    v_mfma_f32_16x16x32_bf16 v[88:91], v[192:195], v[200:203], v[88:91]
    ds_read_b128 v[152:155], v34 offset:45056
    v_mfma_f32_16x16x32_bf16 v[120:123], v[192:195], v[204:207], v[120:123]
    ds_read_b128 v[156:159], v34 offset:47104
    s_waitcnt lgkmcnt(10)
    v_mfma_f32_16x16x32_bf16 v[92:95], v[196:199], v[200:203], v[92:95]
    v_fract_f32 v14, v14
    v_cos_f32 v58, v14
    v_mfma_f32_16x16x32_bf16 v[124:127], v[196:199], v[204:207], v[124:127]
    v_sin_f32 v59, v14
    v_mul_f32 v58, v13, v58
    s_waitcnt lgkmcnt(7)
    v_mfma_f32_16x16x32_bf16 v[64:67], v[128:131], v[160:163], v[64:67]
    ds_read_b128 v[200:203], v39 offset:49152
    v_mfma_f32_16x16x32_bf16 v[96:99], v[128:131], v[164:167], v[96:99]
    ds_read_b128 v[204:207], v39 offset:57344
    s_waitcnt lgkmcnt(8)
    v_mfma_f32_16x16x32_bf16 v[68:71], v[132:135], v[160:163], v[68:71]
    v_mul_f32 v59, v13, v59
    s_sub_u32 s58, s4, 1
    v_mfma_f32_16x16x32_bf16 v[100:103], v[132:135], v[164:167], v[100:103]
    ds_read_b128 v[168:171], v35 offset:32768
    s_waitcnt lgkmcnt(8)
    v_mfma_f32_16x16x32_bf16 v[72:75], v[136:139], v[160:163], v[72:75]
    ds_read_b128 v[172:175], v35 offset:34816
    v_mfma_f32_16x16x32_bf16 v[104:107], v[136:139], v[164:167], v[104:107]
    v_sub_u32 v13, s58, v4
    s_movk_i32 s58, 9216
    s_waitcnt lgkmcnt(8)
    v_mfma_f32_16x16x32_bf16 v[76:79], v[140:143], v[160:163], v[76:79]
    ds_read_b128 v[176:179], v35 offset:36864
    v_mfma_f32_16x16x32_bf16 v[108:111], v[140:143], v[164:167], v[108:111]
    ds_read_b128 v[180:183], v35 offset:38912
    s_waitcnt lgkmcnt(9)
    v_mfma_f32_16x16x32_bf16 v[80:83], v[144:147], v[160:163], v[80:83]
    v_lshlrev_b32 v14, 4, v5
    v_add_u32 v14, 8192, v14
    v_mfma_f32_16x16x32_bf16 v[112:115], v[144:147], v[164:167], v[112:115]
    ds_read_b128 v[184:187], v35 offset:40960
    s_waitcnt lgkmcnt(9)
    v_mfma_f32_16x16x32_bf16 v[84:87], v[148:151], v[160:163], v[84:87]
    ds_read_b128 v[188:191], v35 offset:43008
    v_mfma_f32_16x16x32_bf16 v[116:119], v[148:151], v[164:167], v[116:119]
    v_mov_b32 v15, -16
    v_cmp_gt_i32 s[60:61], 0, v13
    s_waitcnt lgkmcnt(9)
    v_mfma_f32_16x16x32_bf16 v[88:91], v[152:155], v[160:163], v[88:91]
    ds_read_b128 v[192:195], v35 offset:45056
    v_mfma_f32_16x16x32_bf16 v[120:123], v[152:155], v[164:167], v[120:123]
    ds_read_b128 v[196:199], v35 offset:47104
    s_waitcnt lgkmcnt(10)
    v_mfma_f32_16x16x32_bf16 v[92:95], v[156:159], v[160:163], v[92:95]
    v_mad_u32_u24 v60, v13, s58, v14
    v_cndmask_b32 v60, v60, v15, s[60:61]
    v_mfma_f32_16x16x32_bf16 v[124:127], v[156:159], v[164:167], v[124:127]
    v_add_u32 v13, -4, v13
    v_cmp_gt_i32 s[62:63], 0, v13
    s_barrier
    s_waitcnt lgkmcnt(7)
    v_mfma_f32_16x16x32_bf16 v[64:67], v[168:171], v[200:203], v[64:67]
    ds_read_b128 v[160:163], v36 offset:16384
    v_mfma_f32_16x16x32_bf16 v[96:99], v[168:171], v[204:207], v[96:99]
    ds_read_b128 v[164:167], v36 offset:24576
    s_waitcnt lgkmcnt(8)
    v_mfma_f32_16x16x32_bf16 v[68:71], v[172:175], v[200:203], v[68:71]
    v_mad_u32_u24 v61, v13, s58, v14
    v_cndmask_b32 v61, v61, v15, s[62:63]
    v_mfma_f32_16x16x32_bf16 v[100:103], v[172:175], v[204:207], v[100:103]
    ds_read_b128 v[128:131], v32 offset:0
    s_waitcnt lgkmcnt(8)
    v_mfma_f32_16x16x32_bf16 v[72:75], v[176:179], v[200:203], v[72:75]
    ds_read_b128 v[132:135], v32 offset:2048
    v_mfma_f32_16x16x32_bf16 v[104:107], v[176:179], v[204:207], v[104:107]
    v_add_u32 v13, -4, v13
    v_cmp_gt_i32 s[64:65], 0, v13
    s_waitcnt lgkmcnt(8)
    v_mfma_f32_16x16x32_bf16 v[76:79], v[180:183], v[200:203], v[76:79]
    ds_read_b128 v[136:139], v32 offset:4096
    v_mfma_f32_16x16x32_bf16 v[108:111], v[180:183], v[204:207], v[108:111]
    ds_read_b128 v[140:143], v32 offset:6144
    s_waitcnt lgkmcnt(9)
    v_mfma_f32_16x16x32_bf16 v[80:83], v[184:187], v[200:203], v[80:83]
    v_mad_u32_u24 v62, v13, s58, v14
    v_cndmask_b32 v62, v62, v15, s[64:65]
    v_mfma_f32_16x16x32_bf16 v[112:115], v[184:187], v[204:207], v[112:115]
    ds_read_b128 v[144:147], v32 offset:8192
    s_waitcnt lgkmcnt(9)
    v_mfma_f32_16x16x32_bf16 v[84:87], v[188:191], v[200:203], v[84:87]
    ds_read_b128 v[148:151], v32 offset:10240
    v_mfma_f32_16x16x32_bf16 v[116:119], v[188:191], v[204:207], v[116:119]
    v_add_u32 v13, -4, v13
    v_cmp_gt_i32 s[66:67], 0, v13
    s_waitcnt lgkmcnt(9)
    v_mfma_f32_16x16x32_bf16 v[88:91], v[192:195], v[200:203], v[88:91]
    ds_read_b128 v[152:155], v32 offset:12288
    v_mfma_f32_16x16x32_bf16 v[120:123], v[192:195], v[204:207], v[120:123]
    ds_read_b128 v[156:159], v32 offset:14336
    s_waitcnt lgkmcnt(10)
    v_mfma_f32_16x16x32_bf16 v[92:95], v[196:199], v[200:203], v[92:95]
    v_mad_u32_u24 v63, v13, s58, v14
    v_cndmask_b32 v63, v63, v15, s[66:67]
    v_mfma_f32_16x16x32_bf16 v[124:127], v[196:199], v[204:207], v[124:127]
    v_add_f32 v13, -1.0, v20
    v_mul_f32 v14, v8, v8
    s_waitcnt lgkmcnt(7)
    v_mfma_f32_16x16x32_bf16 v[64:67], v[128:131], v[160:163], v[64:67]
    ds_read_b128 v[200:203], v37 offset:16384
    v_mfma_f32_16x16x32_bf16 v[96:99], v[128:131], v[164:167], v[96:99]
    ds_read_b128 v[204:207], v37 offset:24576
    s_waitcnt lgkmcnt(8)
    v_mfma_f32_16x16x32_bf16 v[68:71], v[132:135], v[160:163], v[68:71]
    v_fmac_f32 v14, v9, v9
    v_rcp_f32 v14, v14
    v_mfma_f32_16x16x32_bf16 v[100:103], v[132:135], v[164:167], v[100:103]
    ds_read_b128 v[168:171], v33 offset:0
    s_waitcnt lgkmcnt(8)
    v_mfma_f32_16x16x32_bf16 v[72:75], v[136:139], v[160:163], v[72:75]
    ds_read_b128 v[172:175], v33 offset:2048
    v_mfma_f32_16x16x32_bf16 v[104:107], v[136:139], v[164:167], v[104:107]
    v_add_f32 v14, v14, v14
    v_mul_f32 v15, v13, v8
    s_waitcnt lgkmcnt(8)
    v_mfma_f32_16x16x32_bf16 v[76:79], v[140:143], v[160:163], v[76:79]
    ds_read_b128 v[176:179], v33 offset:4096
    v_mfma_f32_16x16x32_bf16 v[108:111], v[140:143], v[164:167], v[108:111]
    ds_read_b128 v[180:183], v33 offset:6144
    s_waitcnt lgkmcnt(9)
    v_mfma_f32_16x16x32_bf16 v[80:83], v[144:147], v[160:163], v[80:83]
    v_fmac_f32 v15, v21, v9
    v_mul_f32 v16, v21, v8
    v_mfma_f32_16x16x32_bf16 v[112:115], v[144:147], v[164:167], v[112:115]
    ds_read_b128 v[184:187], v33 offset:8192
    s_waitcnt lgkmcnt(9)
    v_mfma_f32_16x16x32_bf16 v[84:87], v[148:151], v[160:163], v[84:87]
    ds_read_b128 v[188:191], v33 offset:10240
    v_mfma_f32_16x16x32_bf16 v[116:119], v[148:151], v[164:167], v[116:119]
    v_fma_f32 v16, -v13, v9, v16
    v_mul_f32 v22, v15, v14
    s_waitcnt lgkmcnt(9)
    v_mfma_f32_16x16x32_bf16 v[88:91], v[152:155], v[160:163], v[88:91]
    ds_read_b128 v[192:195], v33 offset:12288
    v_mfma_f32_16x16x32_bf16 v[120:123], v[152:155], v[164:167], v[120:123]
    ds_read_b128 v[196:199], v33 offset:14336
    s_waitcnt lgkmcnt(10)
    v_mfma_f32_16x16x32_bf16 v[92:95], v[156:159], v[160:163], v[92:95]
    v_mul_f32 v23, v16, v14
    v_and_b32 v2, 1, v1
    v_mfma_f32_16x16x32_bf16 v[124:127], v[156:159], v[164:167], v[124:127]
    v_lshlrev_b32 v2, 4, v2
    v_lshlrev_b32 v240, v2, v240
    s_barrier
    s_waitcnt lgkmcnt(7)
    v_mfma_f32_16x16x32_bf16 v[64:67], v[168:171], v[200:203], v[64:67]
    ds_read_b128 v[160:163], v36 offset:49152
    v_mfma_f32_16x16x32_bf16 v[96:99], v[168:171], v[204:207], v[96:99]
    ds_read_b128 v[164:167], v36 offset:57344
    s_waitcnt lgkmcnt(8)
    v_mfma_f32_16x16x32_bf16 v[68:71], v[172:175], v[200:203], v[68:71]
    v_bfe_u32 v2, v1, 1, 4
    v_lshrrev_b32 v232, 5, v1
    v_mfma_f32_16x16x32_bf16 v[100:103], v[172:175], v[204:207], v[100:103]
    ds_read_b128 v[128:131], v32 offset:32768
    s_waitcnt lgkmcnt(8)
    v_mfma_f32_16x16x32_bf16 v[72:75], v[176:179], v[200:203], v[72:75]
    ds_read_b128 v[132:135], v32 offset:34816
    v_mfma_f32_16x16x32_bf16 v[104:107], v[176:179], v[204:207], v[104:107]
    v_lshlrev_b32 v232, 2, v232
    v_sub_u32 v2, v2, v232
    s_waitcnt lgkmcnt(8)
    v_mfma_f32_16x16x32_bf16 v[76:79], v[180:183], v[200:203], v[76:79]
    ds_read_b128 v[136:139], v32 offset:36864
    v_mfma_f32_16x16x32_bf16 v[108:111], v[180:183], v[204:207], v[108:111]
    ds_read_b128 v[140:143], v32 offset:38912
    s_waitcnt lgkmcnt(9)
    v_mfma_f32_16x16x32_bf16 v[80:83], v[184:187], v[200:203], v[80:83]
    v_cmp_eq_u32 vcc, 0, v2
    s_nop 1
    v_cndmask_b32 v232, 0, v240, vcc
    v_mfma_f32_16x16x32_bf16 v[112:115], v[184:187], v[204:207], v[112:115]
    ds_read_b128 v[144:147], v32 offset:40960
    s_waitcnt lgkmcnt(9)
    v_mfma_f32_16x16x32_bf16 v[84:87], v[188:191], v[200:203], v[84:87]
    ds_read_b128 v[148:151], v32 offset:43008
    v_mfma_f32_16x16x32_bf16 v[116:119], v[188:191], v[204:207], v[116:119]
    v_cmp_eq_u32 vcc, 1, v2
    s_nop 1
    v_cndmask_b32 v233, 0, v240, vcc
    s_waitcnt lgkmcnt(9)
    v_mfma_f32_16x16x32_bf16 v[88:91], v[192:195], v[200:203], v[88:91]
    ds_read_b128 v[152:155], v32 offset:45056
    v_mfma_f32_16x16x32_bf16 v[120:123], v[192:195], v[204:207], v[120:123]
    ds_read_b128 v[156:159], v32 offset:47104
    s_waitcnt lgkmcnt(10)
    v_mfma_f32_16x16x32_bf16 v[92:95], v[196:199], v[200:203], v[92:95]
    v_cmp_eq_u32 vcc, 2, v2
    s_nop 1
    v_cndmask_b32 v234, 0, v240, vcc
    v_mfma_f32_16x16x32_bf16 v[124:127], v[196:199], v[204:207], v[124:127]
    v_cmp_eq_u32 vcc, 3, v2
    s_nop 1
    v_cndmask_b32 v235, 0, v240, vcc
    s_waitcnt lgkmcnt(7)
    v_mfma_f32_16x16x32_bf16 v[64:67], v[128:131], v[160:163], v[64:67]
    ds_read_b128 v[200:203], v37 offset:49152
    v_mfma_f32_16x16x32_bf16 v[96:99], v[128:131], v[164:167], v[96:99]
    ds_read_b128 v[204:207], v37 offset:57344
    s_waitcnt lgkmcnt(8)
    v_mfma_f32_16x16x32_bf16 v[68:71], v[132:135], v[160:163], v[68:71]
    v_cmp_eq_u32 vcc, 8, v2
    s_nop 1
    v_cndmask_b32 v236, 0, v240, vcc
    v_mfma_f32_16x16x32_bf16 v[100:103], v[132:135], v[164:167], v[100:103]
    ds_read_b128 v[168:171], v33 offset:32768
    s_waitcnt lgkmcnt(8)
    v_mfma_f32_16x16x32_bf16 v[72:75], v[136:139], v[160:163], v[72:75]
    ds_read_b128 v[172:175], v33 offset:34816
    v_mfma_f32_16x16x32_bf16 v[104:107], v[136:139], v[164:167], v[104:107]
    v_cmp_eq_u32 vcc, 9, v2
    s_nop 1
    v_cndmask_b32 v237, 0, v240, vcc
    s_waitcnt lgkmcnt(8)
    v_mfma_f32_16x16x32_bf16 v[76:79], v[140:143], v[160:163], v[76:79]
    ds_read_b128 v[176:179], v33 offset:36864
    v_mfma_f32_16x16x32_bf16 v[108:111], v[140:143], v[164:167], v[108:111]
    ds_read_b128 v[180:183], v33 offset:38912
    s_waitcnt lgkmcnt(9)
    v_mfma_f32_16x16x32_bf16 v[80:83], v[144:147], v[160:163], v[80:83]
    v_cmp_eq_u32 vcc, 10, v2
    s_nop 1
    v_cndmask_b32 v238, 0, v240, vcc
    v_mfma_f32_16x16x32_bf16 v[112:115], v[144:147], v[164:167], v[112:115]
    ds_read_b128 v[184:187], v33 offset:40960
    s_waitcnt lgkmcnt(9)
    v_mfma_f32_16x16x32_bf16 v[84:87], v[148:151], v[160:163], v[84:87]
    ds_read_b128 v[188:191], v33 offset:43008
    v_mfma_f32_16x16x32_bf16 v[116:119], v[148:151], v[164:167], v[116:119]
    v_cmp_eq_u32 vcc, 11, v2
    s_nop 1
    v_cndmask_b32 v239, 0, v240, vcc
    s_waitcnt lgkmcnt(9)
    v_mfma_f32_16x16x32_bf16 v[88:91], v[152:155], v[160:163], v[88:91]
    ds_read_b128 v[192:195], v33 offset:45056
    v_mfma_f32_16x16x32_bf16 v[120:123], v[152:155], v[164:167], v[120:123]
    ds_read_b128 v[196:199], v33 offset:47104
    s_waitcnt lgkmcnt(10)
    v_mfma_f32_16x16x32_bf16 v[92:95], v[156:159], v[160:163], v[92:95]
    v_mfma_f32_16x16x32_bf16 v[124:127], v[156:159], v[164:167], v[124:127]
    s_barrier
    s_waitcnt lgkmcnt(7)
    v_mfma_f32_16x16x32_bf16 v[64:67], v[168:171], v[200:203], v[64:67]
    ds_read_b128 v[160:163], v38 offset:16384
    v_mfma_f32_16x16x32_bf16 v[96:99], v[168:171], v[204:207], v[96:99]
    ds_read_b128 v[164:167], v38 offset:24576
    s_waitcnt lgkmcnt(8)
    v_mfma_f32_16x16x32_bf16 v[68:71], v[172:175], v[200:203], v[68:71]
    v_mfma_f32_16x16x32_bf16 v[100:103], v[172:175], v[204:207], v[100:103]
    ds_read_b128 v[128:131], v34 offset:0
    s_waitcnt lgkmcnt(8)
    v_mfma_f32_16x16x32_bf16 v[72:75], v[176:179], v[200:203], v[72:75]
    ds_read_b128 v[132:135], v34 offset:2048
    v_mfma_f32_16x16x32_bf16 v[104:107], v[176:179], v[204:207], v[104:107]
    s_waitcnt lgkmcnt(8)
    v_mfma_f32_16x16x32_bf16 v[76:79], v[180:183], v[200:203], v[76:79]
    ds_read_b128 v[136:139], v34 offset:4096
    v_mfma_f32_16x16x32_bf16 v[108:111], v[180:183], v[204:207], v[108:111]
    ds_read_b128 v[140:143], v34 offset:6144
    s_waitcnt lgkmcnt(9)
    v_mfma_f32_16x16x32_bf16 v[80:83], v[184:187], v[200:203], v[80:83]
    v_mfma_f32_16x16x32_bf16 v[112:115], v[184:187], v[204:207], v[112:115]
    ds_read_b128 v[144:147], v34 offset:8192
    s_waitcnt lgkmcnt(9)
    v_mfma_f32_16x16x32_bf16 v[84:87], v[188:191], v[200:203], v[84:87]
    ds_read_b128 v[148:151], v34 offset:10240
    v_mfma_f32_16x16x32_bf16 v[116:119], v[188:191], v[204:207], v[116:119]
    s_waitcnt lgkmcnt(9)
    v_mfma_f32_16x16x32_bf16 v[88:91], v[192:195], v[200:203], v[88:91]
    ds_read_b128 v[152:155], v34 offset:12288
    v_mfma_f32_16x16x32_bf16 v[120:123], v[192:195], v[204:207], v[120:123]
    ds_read_b128 v[156:159], v34 offset:14336
    s_waitcnt lgkmcnt(10)
    v_mfma_f32_16x16x32_bf16 v[92:95], v[196:199], v[200:203], v[92:95]
    v_mfma_f32_16x16x32_bf16 v[124:127], v[196:199], v[204:207], v[124:127]
    s_waitcnt lgkmcnt(7)
    v_mfma_f32_16x16x32_bf16 v[64:67], v[128:131], v[160:163], v[64:67]
    ds_read_b128 v[200:203], v39 offset:16384
    v_mfma_f32_16x16x32_bf16 v[96:99], v[128:131], v[164:167], v[96:99]
    ds_read_b128 v[204:207], v39 offset:24576
    s_waitcnt lgkmcnt(8)
    v_mfma_f32_16x16x32_bf16 v[68:71], v[132:135], v[160:163], v[68:71]
    v_mfma_f32_16x16x32_bf16 v[100:103], v[132:135], v[164:167], v[100:103]
    ds_read_b128 v[168:171], v35 offset:0
    s_waitcnt lgkmcnt(8)
    v_mfma_f32_16x16x32_bf16 v[72:75], v[136:139], v[160:163], v[72:75]
    ds_read_b128 v[172:175], v35 offset:2048
    v_mfma_f32_16x16x32_bf16 v[104:107], v[136:139], v[164:167], v[104:107]
    s_waitcnt lgkmcnt(8)
    v_mfma_f32_16x16x32_bf16 v[76:79], v[140:143], v[160:163], v[76:79]
    ds_read_b128 v[176:179], v35 offset:4096
    v_mfma_f32_16x16x32_bf16 v[108:111], v[140:143], v[164:167], v[108:111]
    ds_read_b128 v[180:183], v35 offset:6144
    s_waitcnt lgkmcnt(9)
    v_mfma_f32_16x16x32_bf16 v[80:83], v[144:147], v[160:163], v[80:83]
    v_mfma_f32_16x16x32_bf16 v[112:115], v[144:147], v[164:167], v[112:115]
    ds_read_b128 v[184:187], v35 offset:8192
    s_waitcnt lgkmcnt(9)
    v_mfma_f32_16x16x32_bf16 v[84:87], v[148:151], v[160:163], v[84:87]
    ds_read_b128 v[188:191], v35 offset:10240
    v_mfma_f32_16x16x32_bf16 v[116:119], v[148:151], v[164:167], v[116:119]
    s_waitcnt lgkmcnt(9)
    v_mfma_f32_16x16x32_bf16 v[88:91], v[152:155], v[160:163], v[88:91]
    ds_read_b128 v[192:195], v35 offset:12288
    v_mfma_f32_16x16x32_bf16 v[120:123], v[152:155], v[164:167], v[120:123]
    ds_read_b128 v[196:199], v35 offset:14336
    s_waitcnt lgkmcnt(10)
    v_mfma_f32_16x16x32_bf16 v[92:95], v[156:159], v[160:163], v[92:95]
    v_mfma_f32_16x16x32_bf16 v[124:127], v[156:159], v[164:167], v[124:127]
    s_barrier
    s_waitcnt lgkmcnt(7)
    v_mfma_f32_16x16x32_bf16 v[64:67], v[168:171], v[200:203], v[64:67]
    ds_read_b128 v[160:163], v38 offset:49152
    v_mfma_f32_16x16x32_bf16 v[96:99], v[168:171], v[204:207], v[96:99]
    ds_read_b128 v[164:167], v38 offset:57344
    s_waitcnt lgkmcnt(8)
    v_mfma_f32_16x16x32_bf16 v[68:71], v[172:175], v[200:203], v[68:71]
    v_mfma_f32_16x16x32_bf16 v[100:103], v[172:175], v[204:207], v[100:103]
    ds_read_b128 v[128:131], v34 offset:32768
    s_waitcnt lgkmcnt(8)
    v_mfma_f32_16x16x32_bf16 v[72:75], v[176:179], v[200:203], v[72:75]
    ds_read_b128 v[132:135], v34 offset:34816
    v_mfma_f32_16x16x32_bf16 v[104:107], v[176:179], v[204:207], v[104:107]
    s_waitcnt lgkmcnt(8)
    v_mfma_f32_16x16x32_bf16 v[76:79], v[180:183], v[200:203], v[76:79]
    ds_read_b128 v[136:139], v34 offset:36864
    v_mfma_f32_16x16x32_bf16 v[108:111], v[180:183], v[204:207], v[108:111]
    ds_read_b128 v[140:143], v34 offset:38912
    s_waitcnt lgkmcnt(9)
    v_mfma_f32_16x16x32_bf16 v[80:83], v[184:187], v[200:203], v[80:83]
    v_mfma_f32_16x16x32_bf16 v[112:115], v[184:187], v[204:207], v[112:115]
    ds_read_b128 v[144:147], v34 offset:40960
    s_waitcnt lgkmcnt(9)
    v_mfma_f32_16x16x32_bf16 v[84:87], v[188:191], v[200:203], v[84:87]
    ds_read_b128 v[148:151], v34 offset:43008
    v_mfma_f32_16x16x32_bf16 v[116:119], v[188:191], v[204:207], v[116:119]
    s_waitcnt lgkmcnt(9)
    v_mfma_f32_16x16x32_bf16 v[88:91], v[192:195], v[200:203], v[88:91]
    ds_read_b128 v[152:155], v34 offset:45056
    v_mfma_f32_16x16x32_bf16 v[120:123], v[192:195], v[204:207], v[120:123]
    ds_read_b128 v[156:159], v34 offset:47104
    s_waitcnt lgkmcnt(10)
    v_mfma_f32_16x16x32_bf16 v[92:95], v[196:199], v[200:203], v[92:95]
    v_mfma_f32_16x16x32_bf16 v[124:127], v[196:199], v[204:207], v[124:127]
    s_waitcnt lgkmcnt(7)
    v_mfma_f32_16x16x32_bf16 v[64:67], v[128:131], v[160:163], v[64:67]
    ds_read_b128 v[200:203], v39 offset:49152
    v_mfma_f32_16x16x32_bf16 v[96:99], v[128:131], v[164:167], v[96:99]
    ds_read_b128 v[204:207], v39 offset:57344
    s_waitcnt lgkmcnt(8)
    v_mfma_f32_16x16x32_bf16 v[68:71], v[132:135], v[160:163], v[68:71]
    v_mfma_f32_16x16x32_bf16 v[100:103], v[132:135], v[164:167], v[100:103]
    ds_read_b128 v[168:171], v35 offset:32768
    s_waitcnt lgkmcnt(8)
    v_mfma_f32_16x16x32_bf16 v[72:75], v[136:139], v[160:163], v[72:75]
    ds_read_b128 v[172:175], v35 offset:34816
    v_mfma_f32_16x16x32_bf16 v[104:107], v[136:139], v[164:167], v[104:107]
    s_waitcnt lgkmcnt(8)
    v_mfma_f32_16x16x32_bf16 v[76:79], v[140:143], v[160:163], v[76:79]
    ds_read_b128 v[176:179], v35 offset:36864
    v_mfma_f32_16x16x32_bf16 v[108:111], v[140:143], v[164:167], v[108:111]
    ds_read_b128 v[180:183], v35 offset:38912
    s_waitcnt lgkmcnt(9)
    v_mfma_f32_16x16x32_bf16 v[80:83], v[144:147], v[160:163], v[80:83]
    v_mfma_f32_16x16x32_bf16 v[112:115], v[144:147], v[164:167], v[112:115]
    ds_read_b128 v[184:187], v35 offset:40960
    s_waitcnt lgkmcnt(9)
    v_mfma_f32_16x16x32_bf16 v[84:87], v[148:151], v[160:163], v[84:87]
    ds_read_b128 v[188:191], v35 offset:43008
    v_mfma_f32_16x16x32_bf16 v[116:119], v[148:151], v[164:167], v[116:119]
    s_waitcnt lgkmcnt(9)
    v_mfma_f32_16x16x32_bf16 v[88:91], v[152:155], v[160:163], v[88:91]
    ds_read_b128 v[192:195], v35 offset:45056
    v_mfma_f32_16x16x32_bf16 v[120:123], v[152:155], v[164:167], v[120:123]
    ds_read_b128 v[196:199], v35 offset:47104
    s_waitcnt lgkmcnt(10)
    v_mfma_f32_16x16x32_bf16 v[92:95], v[156:159], v[160:163], v[92:95]
    v_mfma_f32_16x16x32_bf16 v[124:127], v[156:159], v[164:167], v[124:127]
    s_barrier
    s_waitcnt lgkmcnt(7)
    v_mfma_f32_16x16x32_bf16 v[64:67], v[168:171], v[200:203], v[64:67]
    ds_read_b128 v[160:163], v36 offset:16384
    v_mfma_f32_16x16x32_bf16 v[96:99], v[168:171], v[204:207], v[96:99]
    ds_read_b128 v[164:167], v36 offset:24576
    s_waitcnt lgkmcnt(8)
    v_mfma_f32_16x16x32_bf16 v[68:71], v[172:175], v[200:203], v[68:71]
    v_mfma_f32_16x16x32_bf16 v[100:103], v[172:175], v[204:207], v[100:103]
    ds_read_b128 v[128:131], v32 offset:0
    s_waitcnt lgkmcnt(8)
    v_mfma_f32_16x16x32_bf16 v[72:75], v[176:179], v[200:203], v[72:75]
    ds_read_b128 v[132:135], v32 offset:2048
    v_mfma_f32_16x16x32_bf16 v[104:107], v[176:179], v[204:207], v[104:107]
    s_waitcnt lgkmcnt(8)
    v_mfma_f32_16x16x32_bf16 v[76:79], v[180:183], v[200:203], v[76:79]
    ds_read_b128 v[136:139], v32 offset:4096
    v_mfma_f32_16x16x32_bf16 v[108:111], v[180:183], v[204:207], v[108:111]
    ds_read_b128 v[140:143], v32 offset:6144
    s_waitcnt lgkmcnt(9)
    v_mfma_f32_16x16x32_bf16 v[80:83], v[184:187], v[200:203], v[80:83]
    v_mfma_f32_16x16x32_bf16 v[112:115], v[184:187], v[204:207], v[112:115]
    ds_read_b128 v[144:147], v32 offset:8192
    s_waitcnt lgkmcnt(9)
    v_mfma_f32_16x16x32_bf16 v[84:87], v[188:191], v[200:203], v[84:87]
    ds_read_b128 v[148:151], v32 offset:10240
    v_mfma_f32_16x16x32_bf16 v[116:119], v[188:191], v[204:207], v[116:119]
    s_waitcnt lgkmcnt(9)
    v_mfma_f32_16x16x32_bf16 v[88:91], v[192:195], v[200:203], v[88:91]
    ds_read_b128 v[152:155], v32 offset:12288
    v_mfma_f32_16x16x32_bf16 v[120:123], v[192:195], v[204:207], v[120:123]
    ds_read_b128 v[156:159], v32 offset:14336
    s_waitcnt lgkmcnt(10)
    v_mfma_f32_16x16x32_bf16 v[92:95], v[196:199], v[200:203], v[92:95]
    v_mfma_f32_16x16x32_bf16 v[124:127], v[196:199], v[204:207], v[124:127]
    s_waitcnt lgkmcnt(7)
    v_mfma_f32_16x16x32_bf16 v[64:67], v[128:131], v[160:163], v[64:67]
    ds_read_b128 v[200:203], v37 offset:16384
    v_mfma_f32_16x16x32_bf16 v[96:99], v[128:131], v[164:167], v[96:99]
    ds_read_b128 v[204:207], v37 offset:24576
    s_waitcnt lgkmcnt(8)
    v_mfma_f32_16x16x32_bf16 v[68:71], v[132:135], v[160:163], v[68:71]
    v_mfma_f32_16x16x32_bf16 v[100:103], v[132:135], v[164:167], v[100:103]
    ds_read_b128 v[168:171], v33 offset:0
    s_waitcnt lgkmcnt(8)
    v_mfma_f32_16x16x32_bf16 v[72:75], v[136:139], v[160:163], v[72:75]
    ds_read_b128 v[172:175], v33 offset:2048
    v_mfma_f32_16x16x32_bf16 v[104:107], v[136:139], v[164:167], v[104:107]
    s_waitcnt lgkmcnt(8)
    v_mfma_f32_16x16x32_bf16 v[76:79], v[140:143], v[160:163], v[76:79]
    ds_read_b128 v[176:179], v33 offset:4096
    v_mfma_f32_16x16x32_bf16 v[108:111], v[140:143], v[164:167], v[108:111]
    ds_read_b128 v[180:183], v33 offset:6144
    s_waitcnt lgkmcnt(9)
    v_mfma_f32_16x16x32_bf16 v[80:83], v[144:147], v[160:163], v[80:83]
    v_mfma_f32_16x16x32_bf16 v[112:115], v[144:147], v[164:167], v[112:115]
    ds_read_b128 v[184:187], v33 offset:8192
    s_waitcnt lgkmcnt(9)
    v_mfma_f32_16x16x32_bf16 v[84:87], v[148:151], v[160:163], v[84:87]
    ds_read_b128 v[188:191], v33 offset:10240
    v_mfma_f32_16x16x32_bf16 v[116:119], v[148:151], v[164:167], v[116:119]
    s_waitcnt lgkmcnt(9)
    v_mfma_f32_16x16x32_bf16 v[88:91], v[152:155], v[160:163], v[88:91]
    ds_read_b128 v[192:195], v33 offset:12288
    v_mfma_f32_16x16x32_bf16 v[120:123], v[152:155], v[164:167], v[120:123]
    ds_read_b128 v[196:199], v33 offset:14336
    s_waitcnt lgkmcnt(10)
    v_mfma_f32_16x16x32_bf16 v[92:95], v[156:159], v[160:163], v[92:95]
    v_mfma_f32_16x16x32_bf16 v[124:127], v[156:159], v[164:167], v[124:127]
    ds_read_b128 v[224:227], v241
    v_xor_b32 v241, 32, v241
    ds_read_b128 v[228:231], v241
    s_waitcnt lgkmcnt(0)
    s_barrier
    s_waitcnt lgkmcnt(7)
    v_mfma_f32_16x16x32_bf16 v[64:67], v[168:171], v[200:203], v[64:67]
    v_mfma_f32_16x16x32_bf16 v[96:99], v[168:171], v[204:207], v[96:99]
    s_waitcnt lgkmcnt(6)
    v_mfma_f32_16x16x32_bf16 v[68:71], v[172:175], v[200:203], v[68:71]
    v_mfma_f32_16x16x32_bf16 v[100:103], v[172:175], v[204:207], v[100:103]
    s_waitcnt lgkmcnt(5)
    v_mfma_f32_16x16x32_bf16 v[72:75], v[176:179], v[200:203], v[72:75]
    v_mfma_f32_16x16x32_bf16 v[104:107], v[176:179], v[204:207], v[104:107]
    s_waitcnt lgkmcnt(4)
    v_mfma_f32_16x16x32_bf16 v[76:79], v[180:183], v[200:203], v[76:79]
    v_mfma_f32_16x16x32_bf16 v[108:111], v[180:183], v[204:207], v[108:111]
    s_waitcnt lgkmcnt(3)
    v_mfma_f32_16x16x32_bf16 v[80:83], v[184:187], v[200:203], v[80:83]
    v_mfma_f32_16x16x32_bf16 v[112:115], v[184:187], v[204:207], v[112:115]
    s_waitcnt lgkmcnt(2)
    v_mfma_f32_16x16x32_bf16 v[84:87], v[188:191], v[200:203], v[84:87]
    v_mfma_f32_16x16x32_bf16 v[116:119], v[188:191], v[204:207], v[116:119]
    s_waitcnt lgkmcnt(1)
    v_mfma_f32_16x16x32_bf16 v[88:91], v[192:195], v[200:203], v[88:91]
    v_mfma_f32_16x16x32_bf16 v[120:123], v[192:195], v[204:207], v[120:123]
    s_waitcnt lgkmcnt(0)
    v_mfma_f32_16x16x32_bf16 v[92:95], v[196:199], v[200:203], v[92:95]
    v_mfma_f32_16x16x32_bf16 v[124:127], v[196:199], v[204:207], v[124:127]
    v_pk_fma_f32 v[244:245], v[20:21], v[64:65], v[66:67] op_sel:[0,0,0] op_sel_hi:[0,1,1]
    v_pk_fma_f32 v[246:247], v[20:21], v[96:97], v[98:99] op_sel:[0,0,0] op_sel_hi:[0,1,1]
    v_pk_fma_f32 v[244:245], v[20:21], v[96:97], v[244:245] op_sel:[1,0,0] op_sel_hi:[1,1,1] neg_lo:[1,0,0] neg_hi:[1,0,0]
    v_pk_fma_f32 v[246:247], v[20:21], v[64:65], v[246:247] op_sel:[1,0,0] op_sel_hi:[1,1,1]
    v_pk_fma_f32 v[248:249], v[20:21], v[244:245], v[68:69] op_sel:[0,0,0] op_sel_hi:[0,1,1]
    v_pk_fma_f32 v[250:251], v[20:21], v[246:247], v[100:101] op_sel:[0,0,0] op_sel_hi:[0,1,1]
    v_pk_fma_f32 v[248:249], v[20:21], v[246:247], v[248:249] op_sel:[1,0,0] op_sel_hi:[1,1,1] neg_lo:[1,0,0] neg_hi:[1,0,0]
    v_pk_fma_f32 v[250:251], v[20:21], v[244:245], v[250:251] op_sel:[1,0,0] op_sel_hi:[1,1,1]
    v_pk_fma_f32 v[244:245], v[20:21], v[248:249], v[70:71] op_sel:[0,0,0] op_sel_hi:[0,1,1]
    v_pk_fma_f32 v[246:247], v[20:21], v[250:251], v[102:103] op_sel:[0,0,0] op_sel_hi:[0,1,1]
    v_pk_fma_f32 v[244:245], v[20:21], v[250:251], v[244:245] op_sel:[1,0,0] op_sel_hi:[1,1,1] neg_lo:[1,0,0] neg_hi:[1,0,0]
    v_pk_fma_f32 v[246:247], v[20:21], v[248:249], v[246:247] op_sel:[1,0,0] op_sel_hi:[1,1,1]
    v_pk_fma_f32 v[248:249], v[20:21], v[244:245], v[72:73] op_sel:[0,0,0] op_sel_hi:[0,1,1]
    v_pk_fma_f32 v[250:251], v[20:21], v[246:247], v[104:105] op_sel:[0,0,0] op_sel_hi:[0,1,1]
    v_pk_fma_f32 v[248:249], v[20:21], v[246:247], v[248:249] op_sel:[1,0,0] op_sel_hi:[1,1,1] neg_lo:[1,0,0] neg_hi:[1,0,0]
    v_pk_fma_f32 v[250:251], v[20:21], v[244:245], v[250:251] op_sel:[1,0,0] op_sel_hi:[1,1,1]
    v_pk_fma_f32 v[244:245], v[20:21], v[248:249], v[74:75] op_sel:[0,0,0] op_sel_hi:[0,1,1]
    v_pk_fma_f32 v[246:247], v[20:21], v[250:251], v[106:107] op_sel:[0,0,0] op_sel_hi:[0,1,1]
    v_pk_fma_f32 v[244:245], v[20:21], v[250:251], v[244:245] op_sel:[1,0,0] op_sel_hi:[1,1,1] neg_lo:[1,0,0] neg_hi:[1,0,0]
    v_pk_fma_f32 v[246:247], v[20:21], v[248:249], v[246:247] op_sel:[1,0,0] op_sel_hi:[1,1,1]
    v_pk_fma_f32 v[248:249], v[20:21], v[244:245], v[76:77] op_sel:[0,0,0] op_sel_hi:[0,1,1]
    v_pk_fma_f32 v[250:251], v[20:21], v[246:247], v[108:109] op_sel:[0,0,0] op_sel_hi:[0,1,1]
    v_pk_fma_f32 v[248:249], v[20:21], v[246:247], v[248:249] op_sel:[1,0,0] op_sel_hi:[1,1,1] neg_lo:[1,0,0] neg_hi:[1,0,0]
    v_pk_fma_f32 v[250:251], v[20:21], v[244:245], v[250:251] op_sel:[1,0,0] op_sel_hi:[1,1,1]
    v_pk_fma_f32 v[244:245], v[20:21], v[248:249], v[78:79] op_sel:[0,0,0] op_sel_hi:[0,1,1]
    v_pk_fma_f32 v[246:247], v[20:21], v[250:251], v[110:111] op_sel:[0,0,0] op_sel_hi:[0,1,1]
    v_pk_fma_f32 v[244:245], v[20:21], v[250:251], v[244:245] op_sel:[1,0,0] op_sel_hi:[1,1,1] neg_lo:[1,0,0] neg_hi:[1,0,0]
    v_pk_fma_f32 v[246:247], v[20:21], v[248:249], v[246:247] op_sel:[1,0,0] op_sel_hi:[1,1,1]
    v_pk_fma_f32 v[248:249], v[20:21], v[244:245], v[80:81] op_sel:[0,0,0] op_sel_hi:[0,1,1]
    v_pk_fma_f32 v[250:251], v[20:21], v[246:247], v[112:113] op_sel:[0,0,0] op_sel_hi:[0,1,1]
    v_pk_fma_f32 v[248:249], v[20:21], v[246:247], v[248:249] op_sel:[1,0,0] op_sel_hi:[1,1,1] neg_lo:[1,0,0] neg_hi:[1,0,0]
    v_pk_fma_f32 v[250:251], v[20:21], v[244:245], v[250:251] op_sel:[1,0,0] op_sel_hi:[1,1,1]
    v_pk_fma_f32 v[244:245], v[20:21], v[248:249], v[82:83] op_sel:[0,0,0] op_sel_hi:[0,1,1]
    v_pk_fma_f32 v[246:247], v[20:21], v[250:251], v[114:115] op_sel:[0,0,0] op_sel_hi:[0,1,1]
    v_pk_fma_f32 v[244:245], v[20:21], v[250:251], v[244:245] op_sel:[1,0,0] op_sel_hi:[1,1,1] neg_lo:[1,0,0] neg_hi:[1,0,0]
    v_pk_fma_f32 v[246:247], v[20:21], v[248:249], v[246:247] op_sel:[1,0,0] op_sel_hi:[1,1,1]
    v_pk_fma_f32 v[248:249], v[20:21], v[244:245], v[84:85] op_sel:[0,0,0] op_sel_hi:[0,1,1]
    v_pk_fma_f32 v[250:251], v[20:21], v[246:247], v[116:117] op_sel:[0,0,0] op_sel_hi:[0,1,1]
    v_pk_fma_f32 v[248:249], v[20:21], v[246:247], v[248:249] op_sel:[1,0,0] op_sel_hi:[1,1,1] neg_lo:[1,0,0] neg_hi:[1,0,0]
    v_pk_fma_f32 v[250:251], v[20:21], v[244:245], v[250:251] op_sel:[1,0,0] op_sel_hi:[1,1,1]
    v_pk_fma_f32 v[244:245], v[20:21], v[248:249], v[86:87] op_sel:[0,0,0] op_sel_hi:[0,1,1]
    v_pk_fma_f32 v[246:247], v[20:21], v[250:251], v[118:119] op_sel:[0,0,0] op_sel_hi:[0,1,1]
    v_pk_fma_f32 v[244:245], v[20:21], v[250:251], v[244:245] op_sel:[1,0,0] op_sel_hi:[1,1,1] neg_lo:[1,0,0] neg_hi:[1,0,0]
    v_pk_fma_f32 v[246:247], v[20:21], v[248:249], v[246:247] op_sel:[1,0,0] op_sel_hi:[1,1,1]
    v_pk_fma_f32 v[248:249], v[20:21], v[244:245], v[88:89] op_sel:[0,0,0] op_sel_hi:[0,1,1]
    v_pk_fma_f32 v[250:251], v[20:21], v[246:247], v[120:121] op_sel:[0,0,0] op_sel_hi:[0,1,1]
    v_pk_fma_f32 v[248:249], v[20:21], v[246:247], v[248:249] op_sel:[1,0,0] op_sel_hi:[1,1,1] neg_lo:[1,0,0] neg_hi:[1,0,0]
    v_pk_fma_f32 v[250:251], v[20:21], v[244:245], v[250:251] op_sel:[1,0,0] op_sel_hi:[1,1,1]
    v_pk_fma_f32 v[244:245], v[20:21], v[248:249], v[90:91] op_sel:[0,0,0] op_sel_hi:[0,1,1]
    v_pk_fma_f32 v[246:247], v[20:21], v[250:251], v[122:123] op_sel:[0,0,0] op_sel_hi:[0,1,1]
    v_pk_fma_f32 v[244:245], v[20:21], v[250:251], v[244:245] op_sel:[1,0,0] op_sel_hi:[1,1,1] neg_lo:[1,0,0] neg_hi:[1,0,0]
    v_pk_fma_f32 v[246:247], v[20:21], v[248:249], v[246:247] op_sel:[1,0,0] op_sel_hi:[1,1,1]
    v_pk_fma_f32 v[248:249], v[20:21], v[244:245], v[92:93] op_sel:[0,0,0] op_sel_hi:[0,1,1]
    v_pk_fma_f32 v[250:251], v[20:21], v[246:247], v[124:125] op_sel:[0,0,0] op_sel_hi:[0,1,1]
    v_pk_fma_f32 v[248:249], v[20:21], v[246:247], v[248:249] op_sel:[1,0,0] op_sel_hi:[1,1,1] neg_lo:[1,0,0] neg_hi:[1,0,0]
    v_pk_fma_f32 v[250:251], v[20:21], v[244:245], v[250:251] op_sel:[1,0,0] op_sel_hi:[1,1,1]
    v_pk_fma_f32 v[244:245], v[20:21], v[248:249], v[94:95] op_sel:[0,0,0] op_sel_hi:[0,1,1]
    v_pk_fma_f32 v[246:247], v[20:21], v[250:251], v[126:127] op_sel:[0,0,0] op_sel_hi:[0,1,1]
    v_pk_fma_f32 v[244:245], v[20:21], v[250:251], v[244:245] op_sel:[1,0,0] op_sel_hi:[1,1,1] neg_lo:[1,0,0] neg_hi:[1,0,0]
    v_pk_fma_f32 v[246:247], v[20:21], v[248:249], v[246:247] op_sel:[1,0,0] op_sel_hi:[1,1,1]
    v_fma_f32 v208, v24, v244, v245
    v_fma_f32 v209, v24, v246, v247
    v_fma_f32 v208, -v25, v246, v208
    v_fma_f32 v209, v25, v244, v209
    v_mov_b32 v212, v208
    v_mov_b32 v213, v209
    s_nop 0
    v_permlane32_swap_b32 v208, v212
    v_permlane32_swap_b32 v209, v213
    v_mov_b32 v210, v208
    v_mov_b32 v214, v212
    v_mov_b32 v211, v209
    v_mov_b32 v215, v213
    v_permlane16_swap_b32 v208, v210
    v_permlane16_swap_b32 v212, v214
    v_permlane16_swap_b32 v209, v211
    v_permlane16_swap_b32 v213, v215
    v_mov_b32 v217, v18
    v_mov_b32 v219, v18
    v_lshlrev_b32 v19, 4, v5
    s_mul_i32 s46, s4, 9216
    s_add_u32 s46, s46, 8192
    v_fma_f32 v210, v26, v208, v210
    v_fma_f32 v211, v26, v209, v211
    v_fma_f32 v210, -v27, v209, v210
    v_fma_f32 v211, v27, v208, v211
    v_fma_f32 v212, v26, v210, v212
    v_fma_f32 v213, v26, v211, v213
    v_fma_f32 v212, -v27, v211, v212
    v_fma_f32 v213, v27, v210, v213
    v_fma_f32 v216, v26, v212, v214
    v_fma_f32 v218, v26, v213, v215
    v_fma_f32 v216, -v27, v213, v216
    v_fma_f32 v218, v27, v212, v218
    s_mov_b64 exec, 0xffff
    buffer_store_dwordx4 v[216:219], v19, s[16:19], s46 offen sc1
    s_mov_b64 exec, -1
    v_cmp_eq_u32 vcc, 1, v4
    s_nop 1
    v_cndmask_b32 v52, 0, v208, vcc
    v_cndmask_b32 v53, 0, v209, vcc
    v_cmp_eq_u32 vcc, 2, v4
    s_nop 1
    v_cndmask_b32 v52, v52, v210, vcc
    v_cndmask_b32 v53, v53, v211, vcc
    v_cmp_eq_u32 vcc, 3, v4
    s_nop 1
    v_cndmask_b32 v52, v52, v212, vcc
    v_cndmask_b32 v53, v53, v213, vcc
    v_min_u32 v7, 8, v1
    v_lshlrev_b32 v7, 3, v7
    v_pk_mul_f32 v[54:55], v[22:23], v[64:65] op_sel:[0,0] op_sel_hi:[0,1]
    v_pk_mul_f32 v[56:57], v[22:23], v[64:65] op_sel:[1,0] op_sel_hi:[1,1] neg_lo:[1,0] neg_hi:[1,0]
    v_pk_fma_f32 v[64:65], v[22:23], v[96:97], v[54:55] op_sel:[1,0,0] op_sel_hi:[1,1,1] neg_lo:[1,0,0] neg_hi:[1,0,0]
    v_pk_fma_f32 v[96:97], v[22:23], v[96:97], v[56:57] op_sel:[0,0,0] op_sel_hi:[0,1,1] neg_lo:[1,0,0] neg_hi:[1,0,0]
    v_pk_mul_f32 v[48:49], v[22:23], v[66:67] op_sel:[0,0] op_sel_hi:[0,1]
    v_pk_mul_f32 v[50:51], v[22:23], v[66:67] op_sel:[1,0] op_sel_hi:[1,1] neg_lo:[1,0] neg_hi:[1,0]
    v_pk_fma_f32 v[66:67], v[22:23], v[98:99], v[48:49] op_sel:[1,0,0] op_sel_hi:[1,1,1] neg_lo:[1,0,0] neg_hi:[1,0,0]
    v_pk_fma_f32 v[98:99], v[22:23], v[98:99], v[50:51] op_sel:[0,0,0] op_sel_hi:[0,1,1] neg_lo:[1,0,0] neg_hi:[1,0,0]
    v_pk_mul_f32 v[54:55], v[22:23], v[68:69] op_sel:[0,0] op_sel_hi:[0,1]
    v_pk_mul_f32 v[56:57], v[22:23], v[68:69] op_sel:[1,0] op_sel_hi:[1,1] neg_lo:[1,0] neg_hi:[1,0]
    v_pk_fma_f32 v[68:69], v[22:23], v[100:101], v[54:55] op_sel:[1,0,0] op_sel_hi:[1,1,1] neg_lo:[1,0,0] neg_hi:[1,0,0]
    v_pk_fma_f32 v[100:101], v[22:23], v[100:101], v[56:57] op_sel:[0,0,0] op_sel_hi:[0,1,1] neg_lo:[1,0,0] neg_hi:[1,0,0]
    v_pk_mul_f32 v[48:49], v[22:23], v[70:71] op_sel:[0,0] op_sel_hi:[0,1]
    v_pk_mul_f32 v[50:51], v[22:23], v[70:71] op_sel:[1,0] op_sel_hi:[1,1] neg_lo:[1,0] neg_hi:[1,0]
    v_pk_fma_f32 v[70:71], v[22:23], v[102:103], v[48:49] op_sel:[1,0,0] op_sel_hi:[1,1,1] neg_lo:[1,0,0] neg_hi:[1,0,0]
    v_pk_fma_f32 v[102:103], v[22:23], v[102:103], v[50:51] op_sel:[0,0,0] op_sel_hi:[0,1,1] neg_lo:[1,0,0] neg_hi:[1,0,0]
    v_pk_mul_f32 v[54:55], v[22:23], v[72:73] op_sel:[0,0] op_sel_hi:[0,1]
    v_pk_mul_f32 v[56:57], v[22:23], v[72:73] op_sel:[1,0] op_sel_hi:[1,1] neg_lo:[1,0] neg_hi:[1,0]
    v_pk_fma_f32 v[72:73], v[22:23], v[104:105], v[54:55] op_sel:[1,0,0] op_sel_hi:[1,1,1] neg_lo:[1,0,0] neg_hi:[1,0,0]
    v_pk_fma_f32 v[104:105], v[22:23], v[104:105], v[56:57] op_sel:[0,0,0] op_sel_hi:[0,1,1] neg_lo:[1,0,0] neg_hi:[1,0,0]
    v_pk_mul_f32 v[48:49], v[22:23], v[74:75] op_sel:[0,0] op_sel_hi:[0,1]
    v_pk_mul_f32 v[50:51], v[22:23], v[74:75] op_sel:[1,0] op_sel_hi:[1,1] neg_lo:[1,0] neg_hi:[1,0]
    v_pk_fma_f32 v[74:75], v[22:23], v[106:107], v[48:49] op_sel:[1,0,0] op_sel_hi:[1,1,1] neg_lo:[1,0,0] neg_hi:[1,0,0]
    v_pk_fma_f32 v[106:107], v[22:23], v[106:107], v[50:51] op_sel:[0,0,0] op_sel_hi:[0,1,1] neg_lo:[1,0,0] neg_hi:[1,0,0]
    v_pk_mul_f32 v[54:55], v[22:23], v[76:77] op_sel:[0,0] op_sel_hi:[0,1]
    v_pk_mul_f32 v[56:57], v[22:23], v[76:77] op_sel:[1,0] op_sel_hi:[1,1] neg_lo:[1,0] neg_hi:[1,0]
    v_pk_fma_f32 v[76:77], v[22:23], v[108:109], v[54:55] op_sel:[1,0,0] op_sel_hi:[1,1,1] neg_lo:[1,0,0] neg_hi:[1,0,0]
    v_pk_fma_f32 v[108:109], v[22:23], v[108:109], v[56:57] op_sel:[0,0,0] op_sel_hi:[0,1,1] neg_lo:[1,0,0] neg_hi:[1,0,0]
    v_pk_mul_f32 v[48:49], v[22:23], v[78:79] op_sel:[0,0] op_sel_hi:[0,1]
    v_pk_mul_f32 v[50:51], v[22:23], v[78:79] op_sel:[1,0] op_sel_hi:[1,1] neg_lo:[1,0] neg_hi:[1,0]
    v_pk_fma_f32 v[78:79], v[22:23], v[110:111], v[48:49] op_sel:[1,0,0] op_sel_hi:[1,1,1] neg_lo:[1,0,0] neg_hi:[1,0,0]
    v_pk_fma_f32 v[110:111], v[22:23], v[110:111], v[50:51] op_sel:[0,0,0] op_sel_hi:[0,1,1] neg_lo:[1,0,0] neg_hi:[1,0,0]
    v_pk_mul_f32 v[54:55], v[22:23], v[80:81] op_sel:[0,0] op_sel_hi:[0,1]
    v_pk_mul_f32 v[56:57], v[22:23], v[80:81] op_sel:[1,0] op_sel_hi:[1,1] neg_lo:[1,0] neg_hi:[1,0]
    v_pk_fma_f32 v[80:81], v[22:23], v[112:113], v[54:55] op_sel:[1,0,0] op_sel_hi:[1,1,1] neg_lo:[1,0,0] neg_hi:[1,0,0]
    v_pk_fma_f32 v[112:113], v[22:23], v[112:113], v[56:57] op_sel:[0,0,0] op_sel_hi:[0,1,1] neg_lo:[1,0,0] neg_hi:[1,0,0]
    v_pk_mul_f32 v[48:49], v[22:23], v[82:83] op_sel:[0,0] op_sel_hi:[0,1]
    v_pk_mul_f32 v[50:51], v[22:23], v[82:83] op_sel:[1,0] op_sel_hi:[1,1] neg_lo:[1,0] neg_hi:[1,0]
    v_pk_fma_f32 v[82:83], v[22:23], v[114:115], v[48:49] op_sel:[1,0,0] op_sel_hi:[1,1,1] neg_lo:[1,0,0] neg_hi:[1,0,0]
    v_pk_fma_f32 v[114:115], v[22:23], v[114:115], v[50:51] op_sel:[0,0,0] op_sel_hi:[0,1,1] neg_lo:[1,0,0] neg_hi:[1,0,0]
    v_pk_mul_f32 v[54:55], v[22:23], v[84:85] op_sel:[0,0] op_sel_hi:[0,1]
    v_pk_mul_f32 v[56:57], v[22:23], v[84:85] op_sel:[1,0] op_sel_hi:[1,1] neg_lo:[1,0] neg_hi:[1,0]
    v_pk_fma_f32 v[84:85], v[22:23], v[116:117], v[54:55] op_sel:[1,0,0] op_sel_hi:[1,1,1] neg_lo:[1,0,0] neg_hi:[1,0,0]
    v_pk_fma_f32 v[116:117], v[22:23], v[116:117], v[56:57] op_sel:[0,0,0] op_sel_hi:[0,1,1] neg_lo:[1,0,0] neg_hi:[1,0,0]
    v_pk_mul_f32 v[48:49], v[22:23], v[86:87] op_sel:[0,0] op_sel_hi:[0,1]
    v_pk_mul_f32 v[50:51], v[22:23], v[86:87] op_sel:[1,0] op_sel_hi:[1,1] neg_lo:[1,0] neg_hi:[1,0]
    v_pk_fma_f32 v[86:87], v[22:23], v[118:119], v[48:49] op_sel:[1,0,0] op_sel_hi:[1,1,1] neg_lo:[1,0,0] neg_hi:[1,0,0]
    v_pk_fma_f32 v[118:119], v[22:23], v[118:119], v[50:51] op_sel:[0,0,0] op_sel_hi:[0,1,1] neg_lo:[1,0,0] neg_hi:[1,0,0]
    v_pk_mul_f32 v[54:55], v[22:23], v[88:89] op_sel:[0,0] op_sel_hi:[0,1]
    v_pk_mul_f32 v[56:57], v[22:23], v[88:89] op_sel:[1,0] op_sel_hi:[1,1] neg_lo:[1,0] neg_hi:[1,0]
    v_pk_fma_f32 v[88:89], v[22:23], v[120:121], v[54:55] op_sel:[1,0,0] op_sel_hi:[1,1,1] neg_lo:[1,0,0] neg_hi:[1,0,0]
    v_pk_fma_f32 v[120:121], v[22:23], v[120:121], v[56:57] op_sel:[0,0,0] op_sel_hi:[0,1,1] neg_lo:[1,0,0] neg_hi:[1,0,0]
    v_pk_mul_f32 v[48:49], v[22:23], v[90:91] op_sel:[0,0] op_sel_hi:[0,1]
    v_pk_mul_f32 v[50:51], v[22:23], v[90:91] op_sel:[1,0] op_sel_hi:[1,1] neg_lo:[1,0] neg_hi:[1,0]
    v_pk_fma_f32 v[90:91], v[22:23], v[122:123], v[48:49] op_sel:[1,0,0] op_sel_hi:[1,1,1] neg_lo:[1,0,0] neg_hi:[1,0,0]
    v_pk_fma_f32 v[122:123], v[22:23], v[122:123], v[50:51] op_sel:[0,0,0] op_sel_hi:[0,1,1] neg_lo:[1,0,0] neg_hi:[1,0,0]
    v_pk_mul_f32 v[54:55], v[22:23], v[92:93] op_sel:[0,0] op_sel_hi:[0,1]
    v_pk_mul_f32 v[56:57], v[22:23], v[92:93] op_sel:[1,0] op_sel_hi:[1,1] neg_lo:[1,0] neg_hi:[1,0]
    v_pk_fma_f32 v[92:93], v[22:23], v[124:125], v[54:55] op_sel:[1,0,0] op_sel_hi:[1,1,1] neg_lo:[1,0,0] neg_hi:[1,0,0]
    v_pk_fma_f32 v[124:125], v[22:23], v[124:125], v[56:57] op_sel:[0,0,0] op_sel_hi:[0,1,1] neg_lo:[1,0,0] neg_hi:[1,0,0]
    v_pk_mul_f32 v[48:49], v[22:23], v[94:95] op_sel:[0,0] op_sel_hi:[0,1]
    v_pk_mul_f32 v[50:51], v[22:23], v[94:95] op_sel:[1,0] op_sel_hi:[1,1] neg_lo:[1,0] neg_hi:[1,0]
    v_pk_fma_f32 v[94:95], v[22:23], v[126:127], v[48:49] op_sel:[1,0,0] op_sel_hi:[1,1,1] neg_lo:[1,0,0] neg_hi:[1,0,0]
    v_pk_fma_f32 v[126:127], v[22:23], v[126:127], v[50:51] op_sel:[0,0,0] op_sel_hi:[0,1,1] neg_lo:[1,0,0] neg_hi:[1,0,0]
    s_lshl_b32 s48, s5, 2
    s_add_u32 s48, s48, s3
    s_mul_i32 s50, s4, 294912
    s_lshl_b32 s49, s48, 13
    s_add_u32 s50, s50, s49
    s_add_u32 s50, s50, 1048576
    s_add_u32 s51, s50, 4096
    s_lshl_b32 s52, s4, 8
    s_lshl_b32 s49, s48, 2
    s_add_u32 s52, s52, s49
    s_add_u32 s52, s52, 1024
    v_lshlrev_b32 v6, 4, v1
    v_and_b32 v128, 31, v1
    v_lshrrev_b32 v129, 5, v1
    v_bfe_u32 v130, v128, 1, 3
    v_xor_b32 v130, v130, v129
    v_lshlrev_b32 v128, 7, v128
    s_lshr_b32 s76, s3, 2
    s_lshl_b32 s76, s76, 12
    v_add_u32 v128, s76, v128
    v_xor_b32 v131, 0, v130
    v_lshl_add_u32 v10, v131, 4, v128
    v_xor_b32 v131, 2, v130
    v_lshl_add_u32 v11, v131, 4, v128
    v_xor_b32 v131, 4, v130
    v_lshl_add_u32 v12, v131, 4, v128
    v_xor_b32 v131, 6, v130
    v_lshl_add_u32 v13, v131, 4, v128
    v_bfe_u32 v128, v1, 4, 1
    v_bfe_u32 v130, v1, 1, 1
    v_lshl_add_u32 v128, v128, 1, v130
    v_bfe_u32 v130, v1, 2, 2
    v_lshl_add_u32 v130, v129, 3, v130
    v_lshlrev_b32 v131, 2, v128
    v_xor_b32 v130, v130, v131
    v_lshlrev_b32 v130, 4, v130
    v_lshl_add_u32 v130, v128, 11, v130
    v_and_b32 v131, 1, v1
    v_lshl_add_u32 v130, v131, 3, v130
    s_and_b32 s76, s3, 3
    s_lshl_b32 s76, s76, 8
    v_add_u32 v8, s76, v130
    v_xor_b32 v9, 64, v8
    s_lshr_b32 s76, s3, 1
    s_lshl_b32 s76, s76, 2
    v_xor_b32 v130, s76, v1
    v_lshlrev_b32 v14, 4, v130
    s_lshl_b32 s56, s3, 10
    s_mul_i32 s58, s4, 294912
    s_add_u32 s58, s58, 1048576
    s_add_u32 s58, s58, s56
    s_lshl_b32 s59, s5, 15
    s_add_u32 s59, s59, s58
    s_add_u32 s80, s58, 294912
    v_min_u32 v16, 35, v1
    v_lshlrev_b32 v16, 2, v16
    s_lshl_b32 s81, s4, 8
    s_add_u32 s81, s81, 1024
    s_mov_b32 s24, s40
    s_and_b32 s25, s41, 0xffff
    s_mov_b32 s26, 0x900000
    s_mov_b32 s27, 0x00020000
    v_mov_b32 v15, v242
    v_mfma_f32_32x32x16_bf16 v[32:47], v[224:227], v[232:235], 0
    v_mfma_f32_32x32x16_bf16 v[32:47], v[228:231], v[236:239], v[32:47]
    buffer_load_dwordx2 v[220:221], v7, s[16:19], s55 offen sc1
    buffer_load_dwordx4 v[192:195], v60, s[16:19], 0 offen sc1
    buffer_load_dwordx4 v[196:199], v61, s[16:19], 0 offen sc1
    buffer_load_dwordx4 v[200:203], v62, s[16:19], 0 offen sc1
    buffer_load_dwordx4 v[204:207], v63, s[16:19], 0 offen sc1
    s_barrier
    ds_read_b128 v[128:131], v10 offset:32768
    ds_read_b128 v[132:135], v10 offset:40960
    ds_read_b128 v[136:139], v11 offset:32768
    ds_read_b128 v[140:143], v11 offset:40960
    ds_read_b128 v[144:147], v12 offset:32768
    ds_read_b128 v[148:151], v12 offset:40960
    ds_read_b128 v[152:155], v13 offset:32768
    ds_read_b128 v[156:159], v13 offset:40960
    ds_read_b128 v[160:163], v10 offset:49152
    ds_read_b128 v[164:167], v10 offset:57344
    ds_read_b128 v[168:171], v11 offset:49152
    ds_read_b128 v[172:175], v11 offset:57344
    ds_read_b128 v[176:179], v12 offset:49152
    ds_read_b128 v[180:183], v12 offset:57344
    ds_read_b128 v[184:187], v13 offset:49152
    ds_read_b128 v[188:191], v13 offset:57344
    v_add_u32 v10, 0x10000, v10
    v_add_u32 v11, 0x10000, v11
    v_add_u32 v12, 0x10000, v12
    v_add_u32 v13, 0x10000, v13
    ds_read_b128 v[224:227], v10 offset:16384
    ds_read_b128 v[228:231], v10 offset:24576
    ds_read_b128 v[232:235], v11 offset:16384
    ds_read_b128 v[236:239], v11 offset:24576
    v_add_u32 v10, 0xffff0000, v10
    v_add_u32 v11, 0xffff0000, v11
    v_add_u32 v12, 0xffff0000, v12
    v_add_u32 v13, 0xffff0000, v13
    s_mov_b32 s53, 0x100000
    s_nop 0
L_lb_loop:
    s_waitcnt vmcnt(0)
    v_cmp_eq_u32 s[68:69], v18, v193
    v_cmp_eq_u32 s[70:71], v18, v195
    s_nop 0
    s_and_b64 s[68:69], s[68:69], s[70:71]
    s_or_b64 s[48:49], s[68:69], s[60:61]
    v_cmp_eq_u32 s[72:73], v18, v197
    v_cmp_eq_u32 s[74:75], v18, v199
    s_nop 0
    s_and_b64 s[72:73], s[72:73], s[74:75]
    s_or_b64 s[72:73], s[72:73], s[62:63]
    s_and_b64 s[48:49], s[48:49], s[72:73]
    v_cmp_eq_u32 s[68:69], v18, v201
    v_cmp_eq_u32 s[70:71], v18, v203
    s_nop 0
    s_and_b64 s[68:69], s[68:69], s[70:71]
    s_or_b64 s[68:69], s[68:69], s[64:65]
    s_and_b64 s[48:49], s[48:49], s[68:69]
    v_cmp_eq_u32 s[72:73], v18, v205
    v_cmp_eq_u32 s[74:75], v18, v207
    s_nop 0
    s_and_b64 s[72:73], s[72:73], s[74:75]
    s_or_b64 s[72:73], s[72:73], s[66:67]
    s_and_b64 s[48:49], s[48:49], s[72:73]
    s_cmp_eq_u64 s[48:49], -1
    s_cbranch_scc1 L_lb_ok0
    buffer_load_dwordx4 v[192:195], v60, s[16:19], 0 offen sc1
    buffer_load_dwordx4 v[196:199], v61, s[16:19], 0 offen sc1
    buffer_load_dwordx4 v[200:203], v62, s[16:19], 0 offen sc1
    buffer_load_dwordx4 v[204:207], v63, s[16:19], 0 offen sc1
    s_sub_u32 s53, s53, 1
    s_cbranch_scc0 L_lb_loop
L_lb_ok0:
    v_fma_f32 v54, v28, v204, v200
    v_fma_f32 v55, v28, v206, v202
    v_fma_f32 v54, -v29, v206, v54
    v_fma_f32 v55, v29, v204, v55
    v_fma_f32 v56, v28, v54, v196
    v_fma_f32 v57, v28, v55, v198
    v_fma_f32 v56, -v29, v55, v56
    v_fma_f32 v57, v29, v54, v57
    v_fma_f32 v54, v28, v56, v192
    v_fma_f32 v55, v28, v57, v194
    v_fma_f32 v54, -v29, v57, v54
    v_fma_f32 v55, v29, v56, v55
    s_nop 1
L_lb_out:
    v_cmp_eq_u32 vcc, v18, v220
    s_nop 0
    s_cmp_eq_u64 vcc, -1
    s_nop 2
    s_cbranch_scc0 L_xc
L_xoc:
    v_cmp_eq_u32 vcc, s54, v221
    s_nop 0
    s_cmp_eq_u64 vcc, -1
    s_cselect_b32 s57, 1, 0
    v_mul_f32 v56, v58, v54
    v_mul_f32 v57, v58, v55
    v_fma_f32 v56, -v59, v55, v56
    v_fmac_f32 v57, v59, v54
    v_mov_b32 v54, v56
    v_mov_b32 v55, v57
    s_nop 0
    v_permlane32_swap_b32 v54, v56
    v_permlane32_swap_b32 v55, v57
    v_add_f32 v56, v54, v56
    v_add_f32 v57, v55, v57
    v_mov_b32 v54, v56
    v_mov_b32 v55, v57
    s_nop 0
    v_permlane16_swap_b32 v54, v56
    v_permlane16_swap_b32 v55, v57
    v_add_f32 v56, v54, v56
    v_add_f32 v57, v55, v57
    v_fma_f32 v248, v30, v56, v52
    v_fma_f32 v250, v30, v57, v53
    v_fma_f32 v248, -v31, v57, v248
    v_fma_f32 v250, v31, v56, v250
    v_fma_f32 v249, v24, v248, v244
    v_fma_f32 v251, v24, v250, v246
    v_fma_f32 v249, -v25, v250, v249
    v_fma_f32 v251, v25, v248, v251
    v_pk_mul_f32 v[244:245], v[22:23], v[248:249] op_sel:[0,0] op_sel_hi:[0,1]
    v_pk_mul_f32 v[246:247], v[22:23], v[248:249] op_sel:[1,0] op_sel_hi:[1,1] neg_lo:[1,0] neg_hi:[1,0]
    v_pk_fma_f32 v[244:245], v[22:23], v[250:251], v[244:245] op_sel:[1,0,0] op_sel_hi:[1,1,1] neg_lo:[1,0,0] neg_hi:[1,0,0]
    v_pk_fma_f32 v[246:247], v[22:23], v[250:251], v[246:247] op_sel:[0,0,0] op_sel_hi:[0,1,1] neg_lo:[1,0,0] neg_hi:[1,0,0]
    v_pk_fma_f32 v[64:65], v[20:21], v[244:245], v[64:65] op_sel:[0,0,0] op_sel_hi:[0,1,1]
    v_pk_fma_f32 v[96:97], v[20:21], v[246:247], v[96:97] op_sel:[0,0,0] op_sel_hi:[0,1,1]
    v_pk_fma_f32 v[64:65], v[20:21], v[246:247], v[64:65] op_sel:[1,0,0] op_sel_hi:[1,1,1]
    v_pk_fma_f32 v[96:97], v[20:21], v[244:245], v[96:97] op_sel:[1,0,0] op_sel_hi:[1,1,1] neg_lo:[1,0,0] neg_hi:[1,0,0]
    v_pk_fma_f32 v[66:67], v[20:21], v[64:65], v[66:67] op_sel:[0,0,0] op_sel_hi:[0,1,1]
    v_pk_fma_f32 v[98:99], v[20:21], v[96:97], v[98:99] op_sel:[0,0,0] op_sel_hi:[0,1,1]
    v_pk_fma_f32 v[66:67], v[20:21], v[96:97], v[66:67] op_sel:[1,0,0] op_sel_hi:[1,1,1]
    v_pk_fma_f32 v[98:99], v[20:21], v[64:65], v[98:99] op_sel:[1,0,0] op_sel_hi:[1,1,1] neg_lo:[1,0,0] neg_hi:[1,0,0]
    v_cvt_pk_bf16_f32 v192, v64, v66
    v_cvt_pk_bf16_f32 v200, v65, v67
    v_cvt_pk_bf16_f32 v208, v96, v98
    v_cvt_pk_bf16_f32 v216, v97, v99
    v_pk_fma_f32 v[68:69], v[20:21], v[66:67], v[68:69] op_sel:[0,0,0] op_sel_hi:[0,1,1]
    v_pk_fma_f32 v[100:101], v[20:21], v[98:99], v[100:101] op_sel:[0,0,0] op_sel_hi:[0,1,1]
    v_pk_fma_f32 v[68:69], v[20:21], v[98:99], v[68:69] op_sel:[1,0,0] op_sel_hi:[1,1,1]
    v_pk_fma_f32 v[100:101], v[20:21], v[66:67], v[100:101] op_sel:[1,0,0] op_sel_hi:[1,1,1] neg_lo:[1,0,0] neg_hi:[1,0,0]
    v_pk_fma_f32 v[70:71], v[20:21], v[68:69], v[70:71] op_sel:[0,0,0] op_sel_hi:[0,1,1]
    v_pk_fma_f32 v[102:103], v[20:21], v[100:101], v[102:103] op_sel:[0,0,0] op_sel_hi:[0,1,1]
    v_pk_fma_f32 v[70:71], v[20:21], v[100:101], v[70:71] op_sel:[1,0,0] op_sel_hi:[1,1,1]
    v_pk_fma_f32 v[102:103], v[20:21], v[68:69], v[102:103] op_sel:[1,0,0] op_sel_hi:[1,1,1] neg_lo:[1,0,0] neg_hi:[1,0,0]
    v_cvt_pk_bf16_f32 v193, v68, v70
    v_cvt_pk_bf16_f32 v201, v69, v71
    v_cvt_pk_bf16_f32 v209, v100, v102
    v_cvt_pk_bf16_f32 v217, v101, v103
    v_pk_fma_f32 v[72:73], v[20:21], v[70:71], v[72:73] op_sel:[0,0,0] op_sel_hi:[0,1,1]
    v_pk_fma_f32 v[104:105], v[20:21], v[102:103], v[104:105] op_sel:[0,0,0] op_sel_hi:[0,1,1]
    v_pk_fma_f32 v[72:73], v[20:21], v[102:103], v[72:73] op_sel:[1,0,0] op_sel_hi:[1,1,1]
    v_pk_fma_f32 v[104:105], v[20:21], v[70:71], v[104:105] op_sel:[1,0,0] op_sel_hi:[1,1,1] neg_lo:[1,0,0] neg_hi:[1,0,0]
    v_pk_fma_f32 v[74:75], v[20:21], v[72:73], v[74:75] op_sel:[0,0,0] op_sel_hi:[0,1,1]
    v_pk_fma_f32 v[106:107], v[20:21], v[104:105], v[106:107] op_sel:[0,0,0] op_sel_hi:[0,1,1]
    v_pk_fma_f32 v[74:75], v[20:21], v[104:105], v[74:75] op_sel:[1,0,0] op_sel_hi:[1,1,1]
    v_pk_fma_f32 v[106:107], v[20:21], v[72:73], v[106:107] op_sel:[1,0,0] op_sel_hi:[1,1,1] neg_lo:[1,0,0] neg_hi:[1,0,0]
    v_cvt_pk_bf16_f32 v194, v72, v74
    v_cvt_pk_bf16_f32 v202, v73, v75
    v_cvt_pk_bf16_f32 v210, v104, v106
    v_cvt_pk_bf16_f32 v218, v105, v107
    v_pk_fma_f32 v[76:77], v[20:21], v[74:75], v[76:77] op_sel:[0,0,0] op_sel_hi:[0,1,1]
    v_pk_fma_f32 v[108:109], v[20:21], v[106:107], v[108:109] op_sel:[0,0,0] op_sel_hi:[0,1,1]
    v_pk_fma_f32 v[76:77], v[20:21], v[106:107], v[76:77] op_sel:[1,0,0] op_sel_hi:[1,1,1]
    v_pk_fma_f32 v[108:109], v[20:21], v[74:75], v[108:109] op_sel:[1,0,0] op_sel_hi:[1,1,1] neg_lo:[1,0,0] neg_hi:[1,0,0]
    v_pk_fma_f32 v[78:79], v[20:21], v[76:77], v[78:79] op_sel:[0,0,0] op_sel_hi:[0,1,1]
    v_pk_fma_f32 v[110:111], v[20:21], v[108:109], v[110:111] op_sel:[0,0,0] op_sel_hi:[0,1,1]
    v_pk_fma_f32 v[78:79], v[20:21], v[108:109], v[78:79] op_sel:[1,0,0] op_sel_hi:[1,1,1]
    v_pk_fma_f32 v[110:111], v[20:21], v[76:77], v[110:111] op_sel:[1,0,0] op_sel_hi:[1,1,1] neg_lo:[1,0,0] neg_hi:[1,0,0]
    v_cvt_pk_bf16_f32 v195, v76, v78
    v_cvt_pk_bf16_f32 v203, v77, v79
    v_cvt_pk_bf16_f32 v211, v108, v110
    v_cvt_pk_bf16_f32 v219, v109, v111
    s_cmp_eq_u32 s57, 1
    s_cbranch_scc0 L_hs0
    buffer_store_dwordx4 v[192:195], v6, s[16:19], s50 offen offset:0
    buffer_store_dwordx4 v[200:203], v6, s[16:19], s51 offen offset:0
    buffer_store_dwordx4 v[208:211], v6, s[16:19], s50 offen offset:1024
    buffer_store_dwordx4 v[216:219], v6, s[16:19], s51 offen offset:1024
    s_nop 1
L_hr0:
    v_pk_fma_f32 v[80:81], v[20:21], v[78:79], v[80:81] op_sel:[0,0,0] op_sel_hi:[0,1,1]
    v_pk_fma_f32 v[112:113], v[20:21], v[110:111], v[112:113] op_sel:[0,0,0] op_sel_hi:[0,1,1]
    v_pk_fma_f32 v[80:81], v[20:21], v[110:111], v[80:81] op_sel:[1,0,0] op_sel_hi:[1,1,1]
    v_pk_fma_f32 v[112:113], v[20:21], v[78:79], v[112:113] op_sel:[1,0,0] op_sel_hi:[1,1,1] neg_lo:[1,0,0] neg_hi:[1,0,0]
    v_pk_fma_f32 v[82:83], v[20:21], v[80:81], v[82:83] op_sel:[0,0,0] op_sel_hi:[0,1,1]
    v_pk_fma_f32 v[114:115], v[20:21], v[112:113], v[114:115] op_sel:[0,0,0] op_sel_hi:[0,1,1]
    v_pk_fma_f32 v[82:83], v[20:21], v[112:113], v[82:83] op_sel:[1,0,0] op_sel_hi:[1,1,1]
    v_pk_fma_f32 v[114:115], v[20:21], v[80:81], v[114:115] op_sel:[1,0,0] op_sel_hi:[1,1,1] neg_lo:[1,0,0] neg_hi:[1,0,0]
    v_cvt_pk_bf16_f32 v196, v80, v82
    v_cvt_pk_bf16_f32 v204, v81, v83
    v_cvt_pk_bf16_f32 v212, v112, v114
    v_cvt_pk_bf16_f32 v220, v113, v115
    v_pk_fma_f32 v[84:85], v[20:21], v[82:83], v[84:85] op_sel:[0,0,0] op_sel_hi:[0,1,1]
    v_pk_fma_f32 v[116:117], v[20:21], v[114:115], v[116:117] op_sel:[0,0,0] op_sel_hi:[0,1,1]
    v_pk_fma_f32 v[84:85], v[20:21], v[114:115], v[84:85] op_sel:[1,0,0] op_sel_hi:[1,1,1]
    v_pk_fma_f32 v[116:117], v[20:21], v[82:83], v[116:117] op_sel:[1,0,0] op_sel_hi:[1,1,1] neg_lo:[1,0,0] neg_hi:[1,0,0]
    v_pk_fma_f32 v[86:87], v[20:21], v[84:85], v[86:87] op_sel:[0,0,0] op_sel_hi:[0,1,1]
    v_pk_fma_f32 v[118:119], v[20:21], v[116:117], v[118:119] op_sel:[0,0,0] op_sel_hi:[0,1,1]
    v_pk_fma_f32 v[86:87], v[20:21], v[116:117], v[86:87] op_sel:[1,0,0] op_sel_hi:[1,1,1]
    v_pk_fma_f32 v[118:119], v[20:21], v[84:85], v[118:119] op_sel:[1,0,0] op_sel_hi:[1,1,1] neg_lo:[1,0,0] neg_hi:[1,0,0]
    v_cvt_pk_bf16_f32 v197, v84, v86
    v_cvt_pk_bf16_f32 v205, v85, v87
    v_cvt_pk_bf16_f32 v213, v116, v118
    v_cvt_pk_bf16_f32 v221, v117, v119
    v_pk_fma_f32 v[88:89], v[20:21], v[86:87], v[88:89] op_sel:[0,0,0] op_sel_hi:[0,1,1]
    v_pk_fma_f32 v[120:121], v[20:21], v[118:119], v[120:121] op_sel:[0,0,0] op_sel_hi:[0,1,1]
    v_pk_fma_f32 v[88:89], v[20:21], v[118:119], v[88:89] op_sel:[1,0,0] op_sel_hi:[1,1,1]
    v_pk_fma_f32 v[120:121], v[20:21], v[86:87], v[120:121] op_sel:[1,0,0] op_sel_hi:[1,1,1] neg_lo:[1,0,0] neg_hi:[1,0,0]
    v_pk_fma_f32 v[90:91], v[20:21], v[88:89], v[90:91] op_sel:[0,0,0] op_sel_hi:[0,1,1]
    v_pk_fma_f32 v[122:123], v[20:21], v[120:121], v[122:123] op_sel:[0,0,0] op_sel_hi:[0,1,1]
    v_pk_fma_f32 v[90:91], v[20:21], v[120:121], v[90:91] op_sel:[1,0,0] op_sel_hi:[1,1,1]
    v_pk_fma_f32 v[122:123], v[20:21], v[88:89], v[122:123] op_sel:[1,0,0] op_sel_hi:[1,1,1] neg_lo:[1,0,0] neg_hi:[1,0,0]
    v_cvt_pk_bf16_f32 v198, v88, v90
    v_cvt_pk_bf16_f32 v206, v89, v91
    v_cvt_pk_bf16_f32 v214, v120, v122
    v_cvt_pk_bf16_f32 v222, v121, v123
    v_pk_fma_f32 v[92:93], v[20:21], v[90:91], v[92:93] op_sel:[0,0,0] op_sel_hi:[0,1,1]
    v_pk_fma_f32 v[124:125], v[20:21], v[122:123], v[124:125] op_sel:[0,0,0] op_sel_hi:[0,1,1]
    v_pk_fma_f32 v[92:93], v[20:21], v[122:123], v[92:93] op_sel:[1,0,0] op_sel_hi:[1,1,1]
    v_pk_fma_f32 v[124:125], v[20:21], v[90:91], v[124:125] op_sel:[1,0,0] op_sel_hi:[1,1,1] neg_lo:[1,0,0] neg_hi:[1,0,0]
    v_pk_fma_f32 v[94:95], v[20:21], v[92:93], v[94:95] op_sel:[0,0,0] op_sel_hi:[0,1,1]
    v_pk_fma_f32 v[126:127], v[20:21], v[124:125], v[126:127] op_sel:[0,0,0] op_sel_hi:[0,1,1]
    v_pk_fma_f32 v[94:95], v[20:21], v[124:125], v[94:95] op_sel:[1,0,0] op_sel_hi:[1,1,1]
    v_pk_fma_f32 v[126:127], v[20:21], v[92:93], v[126:127] op_sel:[1,0,0] op_sel_hi:[1,1,1] neg_lo:[1,0,0] neg_hi:[1,0,0]
    v_cvt_pk_bf16_f32 v199, v92, v94
    v_cvt_pk_bf16_f32 v207, v93, v95
    v_cvt_pk_bf16_f32 v215, v124, v126
    v_cvt_pk_bf16_f32 v223, v125, v127
    s_cmp_eq_u32 s57, 1
    s_cbranch_scc0 L_hs1
    buffer_store_dwordx4 v[196:199], v6, s[16:19], s50 offen offset:2048
    buffer_store_dwordx4 v[204:207], v6, s[16:19], s51 offen offset:2048
    buffer_store_dwordx4 v[212:215], v6, s[16:19], s50 offen offset:3072
    buffer_store_dwordx4 v[220:223], v6, s[16:19], s51 offen offset:3072
    s_nop 1
L_hr1:
    ds_read_b128 v[64:67], v10 offset:0
    ds_read_b128 v[68:71], v10 offset:8192
    ds_read_b128 v[72:75], v11 offset:0
    ds_read_b128 v[76:79], v11 offset:8192
    ds_read_b128 v[80:83], v12 offset:0
    ds_read_b128 v[84:87], v12 offset:8192
    ds_read_b128 v[88:91], v13 offset:0
    ds_read_b128 v[92:95], v13 offset:8192
    ds_read_b128 v[96:99], v10 offset:16384
    ds_read_b128 v[100:103], v10 offset:24576
    ds_read_b128 v[104:107], v11 offset:16384
    ds_read_b128 v[108:111], v11 offset:24576
    ds_read_b128 v[112:115], v12 offset:16384
    ds_read_b128 v[116:119], v12 offset:24576
    ds_read_b128 v[120:123], v13 offset:16384
    ds_read_b128 v[124:127], v13 offset:24576
    v_add_u32 v10, 0x10000, v10
    v_add_u32 v11, 0x10000, v11
    v_add_u32 v12, 0x10000, v12
    v_add_u32 v13, 0x10000, v13
    ds_read_b128 v[240:243], v12 offset:16384
    ds_read_b128 v[244:247], v12 offset:24576
    ds_read_b128 v[248:251], v13 offset:16384
    ds_read_b128 v[252:255], v13 offset:24576
    s_waitcnt vmcnt(0)
    s_mov_b64 exec, 1
    s_cmp_eq_u32 s57, 1
    s_cbranch_scc0 L_fs
    buffer_store_dword v18, v17, s[16:19], s52 offen
L_fr:
    s_mov_b64 exec, -1
    s_waitcnt lgkmcnt(0)
    s_barrier
    s_add_u32 m0, s56, 32768
    s_nop 0
    buffer_load_dwordx4 v14, s[16:19], s59 offen sc1 lds
    s_add_u32 s59, s59, 8192
    s_add_u32 m0, s56, 40960
    s_nop 0
    buffer_load_dwordx4 v14, s[16:19], s59 offen sc1 lds
    s_add_u32 s59, s59, 8192
    s_add_u32 m0, s56, 49152
    s_nop 0
    buffer_load_dwordx4 v14, s[16:19], s59 offen sc1 lds
    s_add_u32 s59, s59, 8192
    s_add_u32 m0, s56, 57344
    s_nop 0
    buffer_load_dwordx4 v14, s[16:19], s59 offen sc1 lds
    s_add_u32 s59, s59, 8192
    s_cmp_ge_u32 s59, s80
    s_cselect_b32 s59, s58, s59
    ds_read_b128 v[192:195], v10 offset:0
    ds_read_b128 v[196:199], v10 offset:8192
    ds_read_b128 v[200:203], v11 offset:0
    ds_read_b128 v[204:207], v11 offset:8192
    ds_read_b128 v[208:211], v12 offset:0
    ds_read_b128 v[212:215], v12 offset:8192
    ds_read_b128 v[216:219], v13 offset:0
    ds_read_b128 v[220:223], v13 offset:8192
    v_add_u32 v10, 49152, v10
    v_add_u32 v11, 49152, v11
    v_add_u32 v12, 49152, v12
    v_add_u32 v13, 49152, v13
    s_nop 1
L_g2main:
    s_mov_b32 s64, 0
    s_mov_b32 s65, 4608
    s_mov_b32 s66, 9216
    s_mov_b32 s67, 13824
    s_mov_b32 s68, 36864
    s_mov_b32 s69, 41472
    s_mov_b32 s70, 46080
    s_mov_b32 s71, 50688
    s_mov_b32 s72, 73728
    s_mov_b32 s73, 78336
    s_mov_b32 s74, 82944
    s_mov_b32 s75, 87552
    s_mov_b32 s76, 110592
    s_mov_b32 s77, 115200
    s_mov_b32 s78, 119808
    s_mov_b32 s79, 124416
    s_waitcnt lgkmcnt(0)
    s_barrier
    v_mov_b32 v24, v18
    s_lshl_b32 s62, s5, 2
    v_min_u32 v25, 35, v1
    v_add_u32 v25, s62, v25
    v_subrev_u32 v26, 36, v25
    v_min_u32 v25, v25, v26
    v_lshlrev_b32 v25, 2, v25
    s_mov_b32 s53, 0x100000
    s_nop 0
L_gp1:
    s_sub_u32 s53, s53, 1
    s_cbranch_scc1 L_gr1
    buffer_load_dword v2, v25, s[16:19], s81 offen sc1
    s_waitcnt vmcnt(0)
    v_cmp_eq_u32 s[60:61], v2, v24
    s_nop 0
    s_cmp_eq_u64 s[60:61], -1
    s_nop 2
    s_cbranch_scc1 L_gr1
    s_sleep 2
    s_branch L_gp1
L_gr1:
    s_add_u32 m0, s56, 65536
    s_nop 0
    buffer_load_dwordx4 v14, s[16:19], s59 offen sc1 lds
    s_add_u32 s59, s59, 8192
    s_add_u32 m0, s56, 73728
    s_nop 0
    buffer_load_dwordx4 v14, s[16:19], s59 offen sc1 lds
    s_add_u32 s59, s59, 8192
    s_add_u32 m0, s56, 81920
    s_nop 0
    buffer_load_dwordx4 v14, s[16:19], s59 offen sc1 lds
    s_add_u32 s59, s59, 8192
    s_add_u32 m0, s56, 90112
    s_nop 0
    buffer_load_dwordx4 v14, s[16:19], s59 offen sc1 lds
    s_add_u32 s59, s59, 8192
    s_cmp_ge_u32 s59, s80
    s_cselect_b32 s59, s58, s59
    s_barrier
    ds_read_b64_tr_b16 v[48:49], v8 offset:32768
    ds_read_b64_tr_b16 v[50:51], v9 offset:32768
    ds_read_b64_tr_b16 v[52:53], v8 offset:33792
    ds_read_b64_tr_b16 v[54:55], v9 offset:33792
    ds_read_b64_tr_b16 v[56:57], v8 offset:40960
    ds_read_b64_tr_b16 v[58:59], v9 offset:40960
    ds_read_b64_tr_b16 v[60:61], v8 offset:41984
    ds_read_b64_tr_b16 v[62:63], v9 offset:41984
    s_add_u32 m0, s56, 0
    s_nop 0
    buffer_load_dwordx4 v14, s[16:19], s59 offen sc1 lds
    s_add_u32 s59, s59, 8192
    s_add_u32 m0, s56, 8192
    s_nop 0
    buffer_load_dwordx4 v14, s[16:19], s59 offen sc1 lds
    s_add_u32 s59, s59, 8192
    s_add_u32 m0, s56, 16384
    s_nop 0
    buffer_load_dwordx4 v14, s[16:19], s59 offen sc1 lds
    s_add_u32 s59, s59, 8192
    s_add_u32 m0, s56, 24576
    s_nop 0
    buffer_load_dwordx4 v14, s[16:19], s59 offen sc1 lds
    s_add_u32 s59, s59, 8192
    s_cmp_ge_u32 s59, s80
    s_cselect_b32 s59, s58, s59
    s_waitcnt lgkmcnt(4)
    v_mfma_f32_32x32x16_bf16 v[32:47], v[48:51], v[64:67], v[32:47]
    ds_read_b64_tr_b16 v[16:17], v8 offset:49152
    ds_read_b64_tr_b16 v[18:19], v9 offset:49152
    ds_read_b64_tr_b16 v[20:21], v8 offset:50176
    ds_read_b64_tr_b16 v[22:23], v9 offset:50176
    v_mfma_f32_32x32x16_bf16 v[32:47], v[52:55], v[68:71], v[32:47]
    s_waitcnt lgkmcnt(4)
    v_mfma_f32_32x32x16_bf16 v[32:47], v[56:59], v[72:75], v[32:47]
    ds_read_b64_tr_b16 v[48:49], v8 offset:57344
    ds_read_b64_tr_b16 v[50:51], v9 offset:57344
    ds_read_b64_tr_b16 v[52:53], v8 offset:58368
    ds_read_b64_tr_b16 v[54:55], v9 offset:58368
    v_mfma_f32_32x32x16_bf16 v[32:47], v[60:63], v[76:79], v[32:47]
    s_waitcnt lgkmcnt(4)
    v_mfma_f32_32x32x16_bf16 v[32:47], v[16:19], v[80:83], v[32:47]
    v_mfma_f32_32x32x16_bf16 v[32:47], v[20:23], v[84:87], v[32:47]
    s_waitcnt lgkmcnt(0)
    s_waitcnt vmcnt(4)
    s_barrier
    v_mfma_f32_32x32x16_bf16 v[32:47], v[48:51], v[88:91], v[32:47]
    v_add_u32 v8, 0x10000, v8
    v_add_u32 v9, 0x10000, v9
    ds_read_b64_tr_b16 v[56:57], v8 offset:0
    ds_read_b64_tr_b16 v[58:59], v9 offset:0
    ds_read_b64_tr_b16 v[60:61], v8 offset:1024
    ds_read_b64_tr_b16 v[62:63], v9 offset:1024
    v_mfma_f32_32x32x16_bf16 v[32:47], v[52:55], v[92:95], v[32:47]
    ds_read_b64_tr_b16 v[16:17], v8 offset:8192
    ds_read_b64_tr_b16 v[18:19], v9 offset:8192
    ds_read_b64_tr_b16 v[20:21], v8 offset:9216
    ds_read_b64_tr_b16 v[22:23], v9 offset:9216
    s_add_u32 m0, s56, 32768
    s_nop 0
    buffer_load_dwordx4 v14, s[16:19], s59 offen sc1 lds
    s_add_u32 s59, s59, 8192
    s_waitcnt lgkmcnt(4)
    v_mfma_f32_32x32x16_bf16 v[32:47], v[56:59], v[96:99], v[32:47]
    ds_read_b64_tr_b16 v[48:49], v8 offset:16384
    ds_read_b64_tr_b16 v[50:51], v9 offset:16384
    ds_read_b64_tr_b16 v[52:53], v8 offset:17408
    ds_read_b64_tr_b16 v[54:55], v9 offset:17408
    v_mfma_f32_32x32x16_bf16 v[32:47], v[60:63], v[100:103], v[32:47]
    s_add_u32 m0, s56, 40960
    s_nop 0
    buffer_load_dwordx4 v14, s[16:19], s59 offen sc1 lds
    s_add_u32 s59, s59, 8192
    s_waitcnt lgkmcnt(4)
    v_mfma_f32_32x32x16_bf16 v[32:47], v[16:19], v[104:107], v[32:47]
    ds_read_b64_tr_b16 v[56:57], v8 offset:24576
    ds_read_b64_tr_b16 v[58:59], v9 offset:24576
    ds_read_b64_tr_b16 v[60:61], v8 offset:25600
    ds_read_b64_tr_b16 v[62:63], v9 offset:25600
    v_mfma_f32_32x32x16_bf16 v[32:47], v[20:23], v[108:111], v[32:47]
    s_add_u32 m0, s56, 49152
    s_nop 0
    buffer_load_dwordx4 v14, s[16:19], s59 offen sc1 lds
    s_add_u32 s59, s59, 8192
    s_waitcnt lgkmcnt(4)
    v_mfma_f32_32x32x16_bf16 v[32:47], v[48:51], v[112:115], v[32:47]
    v_mfma_f32_32x32x16_bf16 v[32:47], v[52:55], v[116:119], v[32:47]
    s_add_u32 m0, s56, 57344
    s_nop 0
    buffer_load_dwordx4 v14, s[16:19], s59 offen sc1 lds
    s_add_u32 s59, s59, 8192
    s_cmp_ge_u32 s59, s80
    s_cselect_b32 s59, s58, s59
    s_waitcnt lgkmcnt(0)
    s_waitcnt vmcnt(4)
    s_barrier
    v_mfma_f32_32x32x16_bf16 v[32:47], v[56:59], v[120:123], v[32:47]
    v_add_u32 v8, 0xffff0000, v8
    v_add_u32 v9, 0xffff0000, v9
    ds_read_b64_tr_b16 v[16:17], v8 offset:0
    ds_read_b64_tr_b16 v[18:19], v9 offset:0
    ds_read_b64_tr_b16 v[20:21], v8 offset:1024
    ds_read_b64_tr_b16 v[22:23], v9 offset:1024
    v_mfma_f32_32x32x16_bf16 v[32:47], v[60:63], v[124:127], v[32:47]
    ds_read_b64_tr_b16 v[48:49], v8 offset:8192
    ds_read_b64_tr_b16 v[50:51], v9 offset:8192
    ds_read_b64_tr_b16 v[52:53], v8 offset:9216
    ds_read_b64_tr_b16 v[54:55], v9 offset:9216
    s_add_u32 m0, s56, 65536
    s_nop 0
    buffer_load_dwordx4 v14, s[16:19], s59 offen sc1 lds
    s_add_u32 s59, s59, 8192
    s_waitcnt lgkmcnt(4)
    v_mfma_f32_32x32x16_bf16 v[32:47], v[16:19], v[128:131], v[32:47]
    ds_read_b64_tr_b16 v[56:57], v8 offset:16384
    ds_read_b64_tr_b16 v[58:59], v9 offset:16384
    ds_read_b64_tr_b16 v[60:61], v8 offset:17408
    ds_read_b64_tr_b16 v[62:63], v9 offset:17408
    v_mfma_f32_32x32x16_bf16 v[32:47], v[20:23], v[132:135], v[32:47]
    s_add_u32 m0, s56, 73728
    s_nop 0
    buffer_load_dwordx4 v14, s[16:19], s59 offen sc1 lds
    s_add_u32 s59, s59, 8192
    s_waitcnt lgkmcnt(4)
    v_mfma_f32_32x32x16_bf16 v[32:47], v[48:51], v[136:139], v[32:47]
    ds_read_b64_tr_b16 v[16:17], v8 offset:24576
    ds_read_b64_tr_b16 v[18:19], v9 offset:24576
    ds_read_b64_tr_b16 v[20:21], v8 offset:25600
    ds_read_b64_tr_b16 v[22:23], v9 offset:25600
    v_mfma_f32_32x32x16_bf16 v[32:47], v[52:55], v[140:143], v[32:47]
    s_add_u32 m0, s56, 81920
    s_nop 0
    buffer_load_dwordx4 v14, s[16:19], s59 offen sc1 lds
    s_add_u32 s59, s59, 8192
    s_waitcnt lgkmcnt(4)
    v_mfma_f32_32x32x16_bf16 v[32:47], v[56:59], v[144:147], v[32:47]
    v_mfma_f32_32x32x16_bf16 v[32:47], v[60:63], v[148:151], v[32:47]
    s_add_u32 m0, s56, 90112
    s_nop 0
    buffer_load_dwordx4 v14, s[16:19], s59 offen sc1 lds
    s_add_u32 s59, s59, 8192
    s_cmp_ge_u32 s59, s80
    s_cselect_b32 s59, s58, s59
    s_waitcnt lgkmcnt(0)
    s_waitcnt vmcnt(4)
    s_barrier
    v_mfma_f32_32x32x16_bf16 v[32:47], v[16:19], v[152:155], v[32:47]
    ds_read_b64_tr_b16 v[48:49], v8 offset:32768
    ds_read_b64_tr_b16 v[50:51], v9 offset:32768
    ds_read_b64_tr_b16 v[52:53], v8 offset:33792
    ds_read_b64_tr_b16 v[54:55], v9 offset:33792
    v_mfma_f32_32x32x16_bf16 v[32:47], v[20:23], v[156:159], v[32:47]
    ds_read_b64_tr_b16 v[56:57], v8 offset:40960
    ds_read_b64_tr_b16 v[58:59], v9 offset:40960
    ds_read_b64_tr_b16 v[60:61], v8 offset:41984
    ds_read_b64_tr_b16 v[62:63], v9 offset:41984
    s_add_u32 m0, s56, 0
    s_nop 0
    buffer_load_dwordx4 v14, s[16:19], s59 offen sc1 lds
    s_add_u32 s59, s59, 8192
    s_waitcnt lgkmcnt(4)
    v_mfma_f32_32x32x16_bf16 v[32:47], v[48:51], v[160:163], v[32:47]
    ds_read_b64_tr_b16 v[16:17], v8 offset:49152
    ds_read_b64_tr_b16 v[18:19], v9 offset:49152
    ds_read_b64_tr_b16 v[20:21], v8 offset:50176
    ds_read_b64_tr_b16 v[22:23], v9 offset:50176
    v_mfma_f32_32x32x16_bf16 v[32:47], v[52:55], v[164:167], v[32:47]
    s_add_u32 m0, s56, 8192
    s_nop 0
    buffer_load_dwordx4 v14, s[16:19], s59 offen sc1 lds
    s_add_u32 s59, s59, 8192
    s_waitcnt lgkmcnt(4)
    v_mfma_f32_32x32x16_bf16 v[32:47], v[56:59], v[168:171], v[32:47]
    ds_read_b64_tr_b16 v[48:49], v8 offset:57344
    ds_read_b64_tr_b16 v[50:51], v9 offset:57344
    ds_read_b64_tr_b16 v[52:53], v8 offset:58368
    ds_read_b64_tr_b16 v[54:55], v9 offset:58368
    v_mfma_f32_32x32x16_bf16 v[32:47], v[60:63], v[172:175], v[32:47]
    s_add_u32 m0, s56, 16384
    s_nop 0
    buffer_load_dwordx4 v14, s[16:19], s59 offen sc1 lds
    s_add_u32 s59, s59, 8192
    s_waitcnt lgkmcnt(4)
    v_mfma_f32_32x32x16_bf16 v[32:47], v[16:19], v[176:179], v[32:47]
    v_mfma_f32_32x32x16_bf16 v[32:47], v[20:23], v[180:183], v[32:47]
    s_add_u32 m0, s56, 24576
    s_nop 0
    buffer_load_dwordx4 v14, s[16:19], s59 offen sc1 lds
    s_add_u32 s59, s59, 8192
    s_cmp_ge_u32 s59, s80
    s_cselect_b32 s59, s58, s59
    s_waitcnt lgkmcnt(0)
    s_waitcnt vmcnt(4)
    s_barrier
    v_mfma_f32_32x32x16_bf16 v[32:47], v[48:51], v[184:187], v[32:47]
    v_add_u32 v8, 0x10000, v8
    v_add_u32 v9, 0x10000, v9
    ds_read_b64_tr_b16 v[56:57], v8 offset:0
    ds_read_b64_tr_b16 v[58:59], v9 offset:0
    ds_read_b64_tr_b16 v[60:61], v8 offset:1024
    ds_read_b64_tr_b16 v[62:63], v9 offset:1024
    v_mfma_f32_32x32x16_bf16 v[32:47], v[52:55], v[188:191], v[32:47]
    ds_read_b64_tr_b16 v[16:17], v8 offset:8192
    ds_read_b64_tr_b16 v[18:19], v9 offset:8192
    ds_read_b64_tr_b16 v[20:21], v8 offset:9216
    ds_read_b64_tr_b16 v[22:23], v9 offset:9216
    s_add_u32 m0, s56, 32768
    s_nop 0
    buffer_load_dwordx4 v14, s[16:19], s59 offen sc1 lds
    s_add_u32 s59, s59, 8192
    s_waitcnt lgkmcnt(4)
    v_mfma_f32_32x32x16_bf16 v[32:47], v[56:59], v[192:195], v[32:47]
    ds_read_b64_tr_b16 v[48:49], v8 offset:16384
    ds_read_b64_tr_b16 v[50:51], v9 offset:16384
    ds_read_b64_tr_b16 v[52:53], v8 offset:17408
    ds_read_b64_tr_b16 v[54:55], v9 offset:17408
    v_mfma_f32_32x32x16_bf16 v[32:47], v[60:63], v[196:199], v[32:47]
    s_add_u32 m0, s56, 40960
    s_nop 0
    buffer_load_dwordx4 v14, s[16:19], s59 offen sc1 lds
    s_add_u32 s59, s59, 8192
    s_waitcnt lgkmcnt(4)
    v_mfma_f32_32x32x16_bf16 v[32:47], v[16:19], v[200:203], v[32:47]
    ds_read_b64_tr_b16 v[56:57], v8 offset:24576
    ds_read_b64_tr_b16 v[58:59], v9 offset:24576
    ds_read_b64_tr_b16 v[60:61], v8 offset:25600
    ds_read_b64_tr_b16 v[62:63], v9 offset:25600
    v_mfma_f32_32x32x16_bf16 v[32:47], v[20:23], v[204:207], v[32:47]
    s_add_u32 m0, s56, 49152
    s_nop 0
    buffer_load_dwordx4 v14, s[16:19], s59 offen sc1 lds
    s_add_u32 s59, s59, 8192
    s_waitcnt lgkmcnt(4)
    v_mfma_f32_32x32x16_bf16 v[32:47], v[48:51], v[208:211], v[32:47]
    v_mfma_f32_32x32x16_bf16 v[32:47], v[52:55], v[212:215], v[32:47]
    s_add_u32 m0, s56, 57344
    s_nop 0
    buffer_load_dwordx4 v14, s[16:19], s59 offen sc1 lds
    s_add_u32 s59, s59, 8192
    s_cmp_ge_u32 s59, s80
    s_cselect_b32 s59, s58, s59
    s_waitcnt lgkmcnt(0)
    s_waitcnt vmcnt(4)
    s_barrier
    v_mfma_f32_32x32x16_bf16 v[32:47], v[56:59], v[216:219], v[32:47]
    v_add_u32 v8, 0xffff0000, v8
    v_add_u32 v9, 0xffff0000, v9
    ds_read_b64_tr_b16 v[16:17], v8 offset:0
    ds_read_b64_tr_b16 v[18:19], v9 offset:0
    ds_read_b64_tr_b16 v[20:21], v8 offset:1024
    ds_read_b64_tr_b16 v[22:23], v9 offset:1024
    v_mfma_f32_32x32x16_bf16 v[32:47], v[60:63], v[220:223], v[32:47]
    ds_read_b64_tr_b16 v[48:49], v8 offset:8192
    ds_read_b64_tr_b16 v[50:51], v9 offset:8192
    ds_read_b64_tr_b16 v[52:53], v8 offset:9216
    ds_read_b64_tr_b16 v[54:55], v9 offset:9216
    s_add_u32 m0, s56, 65536
    s_nop 0
    buffer_load_dwordx4 v14, s[16:19], s59 offen sc1 lds
    s_add_u32 s59, s59, 8192
    s_waitcnt lgkmcnt(4)
    v_mfma_f32_32x32x16_bf16 v[32:47], v[16:19], v[224:227], v[32:47]
    ds_read_b64_tr_b16 v[56:57], v8 offset:16384
    ds_read_b64_tr_b16 v[58:59], v9 offset:16384
    ds_read_b64_tr_b16 v[60:61], v8 offset:17408
    ds_read_b64_tr_b16 v[62:63], v9 offset:17408
    v_mfma_f32_32x32x16_bf16 v[32:47], v[20:23], v[228:231], v[32:47]
    s_add_u32 m0, s56, 73728
    s_nop 0
    buffer_load_dwordx4 v14, s[16:19], s59 offen sc1 lds
    s_add_u32 s59, s59, 8192
    s_waitcnt lgkmcnt(4)
    v_mfma_f32_32x32x16_bf16 v[32:47], v[48:51], v[232:235], v[32:47]
    ds_read_b64_tr_b16 v[16:17], v8 offset:24576
    ds_read_b64_tr_b16 v[18:19], v9 offset:24576
    ds_read_b64_tr_b16 v[20:21], v8 offset:25600
    ds_read_b64_tr_b16 v[22:23], v9 offset:25600
    v_mfma_f32_32x32x16_bf16 v[32:47], v[52:55], v[236:239], v[32:47]
    s_add_u32 m0, s56, 81920
    s_nop 0
    buffer_load_dwordx4 v14, s[16:19], s59 offen sc1 lds
    s_add_u32 s59, s59, 8192
    s_waitcnt lgkmcnt(4)
    v_mfma_f32_32x32x16_bf16 v[32:47], v[56:59], v[240:243], v[32:47]
    v_mfma_f32_32x32x16_bf16 v[32:47], v[60:63], v[244:247], v[32:47]
    s_add_u32 m0, s56, 90112
    s_nop 0
    buffer_load_dwordx4 v14, s[16:19], s59 offen sc1 lds
    s_add_u32 s59, s59, 8192
    s_cmp_ge_u32 s59, s80
    s_cselect_b32 s59, s58, s59
    s_waitcnt lgkmcnt(0)
    s_waitcnt vmcnt(4)
    s_barrier
    v_mfma_f32_32x32x16_bf16 v[32:47], v[16:19], v[248:251], v[32:47]
    ds_read_b64_tr_b16 v[48:49], v8 offset:32768
    ds_read_b64_tr_b16 v[50:51], v9 offset:32768
    ds_read_b64_tr_b16 v[52:53], v8 offset:33792
    ds_read_b64_tr_b16 v[54:55], v9 offset:33792
    ds_read_b128 v[64:67], v10 offset:0
    ds_read_b128 v[68:71], v10 offset:8192
    v_mfma_f32_32x32x16_bf16 v[32:47], v[20:23], v[252:255], v[32:47]
    ds_read_b64_tr_b16 v[56:57], v8 offset:40960
    ds_read_b64_tr_b16 v[58:59], v9 offset:40960
    ds_read_b64_tr_b16 v[60:61], v8 offset:41984
    ds_read_b64_tr_b16 v[62:63], v9 offset:41984
    ds_read_b128 v[72:75], v11 offset:0
    ds_read_b128 v[76:79], v11 offset:8192
    s_add_u32 m0, s56, 0
    s_nop 0
    buffer_load_dwordx4 v14, s[16:19], s59 offen sc1 lds
    s_add_u32 s59, s59, 8192
    s_waitcnt lgkmcnt(6)
    v_mfma_f32_32x32x16_bf16 v[32:47], v[48:51], v[64:67], v[32:47]
    ds_read_b64_tr_b16 v[16:17], v8 offset:49152
    ds_read_b64_tr_b16 v[18:19], v9 offset:49152
    ds_read_b64_tr_b16 v[20:21], v8 offset:50176
    ds_read_b64_tr_b16 v[22:23], v9 offset:50176
    ds_read_b128 v[80:83], v12 offset:0
    ds_read_b128 v[84:87], v12 offset:8192
    v_mfma_f32_32x32x16_bf16 v[32:47], v[52:55], v[68:71], v[32:47]
    s_add_u32 m0, s56, 8192
    s_nop 0
    buffer_load_dwordx4 v14, s[16:19], s59 offen sc1 lds
    s_add_u32 s59, s59, 8192
    s_waitcnt lgkmcnt(6)
    v_mfma_f32_32x32x16_bf16 v[32:47], v[56:59], v[72:75], v[32:47]
    ds_read_b64_tr_b16 v[48:49], v8 offset:57344
    ds_read_b64_tr_b16 v[50:51], v9 offset:57344
    ds_read_b64_tr_b16 v[52:53], v8 offset:58368
    ds_read_b64_tr_b16 v[54:55], v9 offset:58368
    ds_read_b128 v[64:67], v13 offset:0
    ds_read_b128 v[68:71], v13 offset:8192
    v_mfma_f32_32x32x16_bf16 v[32:47], v[60:63], v[76:79], v[32:47]
    s_add_u32 m0, s56, 16384
    s_nop 0
    buffer_load_dwordx4 v14, s[16:19], s59 offen sc1 lds
    s_add_u32 s59, s59, 8192
    s_waitcnt lgkmcnt(6)
    v_mfma_f32_32x32x16_bf16 v[32:47], v[16:19], v[80:83], v[32:47]
    v_mfma_f32_32x32x16_bf16 v[32:47], v[20:23], v[84:87], v[32:47]
    s_add_u32 m0, s56, 24576
    s_nop 0
    buffer_load_dwordx4 v14, s[16:19], s59 offen sc1 lds
    s_add_u32 s59, s59, 8192
    s_cmp_ge_u32 s59, s80
    s_cselect_b32 s59, s58, s59
    s_waitcnt lgkmcnt(0)
    s_waitcnt vmcnt(4)
    s_barrier
    v_mfma_f32_32x32x16_bf16 v[32:47], v[48:51], v[64:67], v[32:47]
    v_add_u32 v8, 0x10000, v8
    v_add_u32 v9, 0x10000, v9
    ds_read_b64_tr_b16 v[56:57], v8 offset:0
    ds_read_b64_tr_b16 v[58:59], v9 offset:0
    ds_read_b64_tr_b16 v[60:61], v8 offset:1024
    ds_read_b64_tr_b16 v[62:63], v9 offset:1024
    ds_read_b128 v[72:75], v10 offset:16384
    ds_read_b128 v[76:79], v10 offset:24576
    v_mfma_f32_32x32x16_bf16 v[32:47], v[52:55], v[68:71], v[32:47]
    ds_read_b64_tr_b16 v[16:17], v8 offset:8192
    ds_read_b64_tr_b16 v[18:19], v9 offset:8192
    ds_read_b64_tr_b16 v[20:21], v8 offset:9216
    ds_read_b64_tr_b16 v[22:23], v9 offset:9216
    ds_read_b128 v[80:83], v11 offset:16384
    ds_read_b128 v[84:87], v11 offset:24576
    s_waitcnt lgkmcnt(6)
    v_mfma_f32_32x32x16_bf16 v[32:47], v[56:59], v[72:75], v[32:47]
    ds_read_b64_tr_b16 v[48:49], v8 offset:16384
    ds_read_b64_tr_b16 v[50:51], v9 offset:16384
    ds_read_b64_tr_b16 v[52:53], v8 offset:17408
    ds_read_b64_tr_b16 v[54:55], v9 offset:17408
    ds_read_b128 v[64:67], v12 offset:16384
    ds_read_b128 v[68:71], v12 offset:24576
    v_mfma_f32_32x32x16_bf16 v[32:47], v[60:63], v[76:79], v[32:47]
    s_waitcnt lgkmcnt(6)
    v_mfma_f32_32x32x16_bf16 v[32:47], v[16:19], v[80:83], v[32:47]
    ds_read_b64_tr_b16 v[56:57], v8 offset:24576
    ds_read_b64_tr_b16 v[58:59], v9 offset:24576
    ds_read_b64_tr_b16 v[60:61], v8 offset:25600
    ds_read_b64_tr_b16 v[62:63], v9 offset:25600
    ds_read_b128 v[72:75], v13 offset:16384
    ds_read_b128 v[76:79], v13 offset:24576
    v_mfma_f32_32x32x16_bf16 v[32:47], v[20:23], v[84:87], v[32:47]
    s_waitcnt lgkmcnt(6)
    v_mfma_f32_32x32x16_bf16 v[32:47], v[48:51], v[64:67], v[32:47]
    v_mfma_f32_32x32x16_bf16 v[32:47], v[52:55], v[68:71], v[32:47]
    s_waitcnt lgkmcnt(0)
    s_waitcnt vmcnt(0)
    s_barrier
    v_mfma_f32_32x32x16_bf16 v[32:47], v[56:59], v[72:75], v[32:47]
    v_add_u32 v8, 0xffff0000, v8
    v_add_u32 v9, 0xffff0000, v9
    ds_read_b64_tr_b16 v[16:17], v8 offset:0
    ds_read_b64_tr_b16 v[18:19], v9 offset:0
    ds_read_b64_tr_b16 v[20:21], v8 offset:1024
    ds_read_b64_tr_b16 v[22:23], v9 offset:1024
    ds_read_b128 v[80:83], v10 offset:32768
    ds_read_b128 v[84:87], v10 offset:40960
    v_mfma_f32_32x32x16_bf16 v[32:47], v[60:63], v[76:79], v[32:47]
    ds_read_b64_tr_b16 v[48:49], v8 offset:8192
    ds_read_b64_tr_b16 v[50:51], v9 offset:8192
    ds_read_b64_tr_b16 v[52:53], v8 offset:9216
    ds_read_b64_tr_b16 v[54:55], v9 offset:9216
    ds_read_b128 v[64:67], v11 offset:32768
    ds_read_b128 v[68:71], v11 offset:40960
    s_waitcnt lgkmcnt(6)
    v_mfma_f32_32x32x16_bf16 v[32:47], v[16:19], v[80:83], v[32:47]
    ds_read_b64_tr_b16 v[56:57], v8 offset:16384
    ds_read_b64_tr_b16 v[58:59], v9 offset:16384
    ds_read_b64_tr_b16 v[60:61], v8 offset:17408
    ds_read_b64_tr_b16 v[62:63], v9 offset:17408
    ds_read_b128 v[72:75], v12 offset:32768
    ds_read_b128 v[76:79], v12 offset:40960
    v_mfma_f32_32x32x16_bf16 v[32:47], v[20:23], v[84:87], v[32:47]
    s_waitcnt lgkmcnt(6)
    v_mfma_f32_32x32x16_bf16 v[32:47], v[48:51], v[64:67], v[32:47]
    ds_read_b64_tr_b16 v[16:17], v8 offset:24576
    ds_read_b64_tr_b16 v[18:19], v9 offset:24576
    ds_read_b64_tr_b16 v[20:21], v8 offset:25600
    ds_read_b64_tr_b16 v[22:23], v9 offset:25600
    ds_read_b128 v[80:83], v13 offset:32768
    ds_read_b128 v[84:87], v13 offset:40960
    v_mfma_f32_32x32x16_bf16 v[32:47], v[52:55], v[68:71], v[32:47]
    s_waitcnt lgkmcnt(6)
    v_mfma_f32_32x32x16_bf16 v[32:47], v[56:59], v[72:75], v[32:47]
    v_mfma_f32_32x32x16_bf16 v[32:47], v[60:63], v[76:79], v[32:47]
    s_waitcnt lgkmcnt(0)
    v_mfma_f32_32x32x16_bf16 v[32:47], v[16:19], v[80:83], v[32:47]
    v_mfma_f32_32x32x16_bf16 v[32:47], v[20:23], v[84:87], v[32:47]
    s_nop 11
    buffer_store_dword v32, v15, s[24:27], s64 offen nt
    buffer_store_dword v33, v15, s[24:27], s65 offen nt
    buffer_store_dword v34, v15, s[24:27], s66 offen nt
    buffer_store_dword v35, v15, s[24:27], s67 offen nt
    buffer_store_dword v36, v15, s[24:27], s68 offen nt
    buffer_store_dword v37, v15, s[24:27], s69 offen nt
    buffer_store_dword v38, v15, s[24:27], s70 offen nt
    buffer_store_dword v39, v15, s[24:27], s71 offen nt
    buffer_store_dword v40, v15, s[24:27], s72 offen nt
    buffer_store_dword v41, v15, s[24:27], s73 offen nt
    buffer_store_dword v42, v15, s[24:27], s74 offen nt
    buffer_store_dword v43, v15, s[24:27], s75 offen nt
    buffer_store_dword v44, v15, s[24:27], s76 offen nt
    buffer_store_dword v45, v15, s[24:27], s77 offen nt
    buffer_store_dword v46, v15, s[24:27], s78 offen nt
    buffer_store_dword v47, v15, s[24:27], s79 offen nt
    s_cmp_lg_u32 s2, 79
    s_cbranch_scc1 L_nobump
    s_cmp_lg_u32 s3, 7
    s_cbranch_scc1 L_nobump
    v_mov_b32 v2, 0
    s_mov_b64 exec, 1
    buffer_store_dword v24, v2, s[16:19], 0 offen sc1
    s_mov_b64 exec, -1
L_nobump:
    s_endpgm
L_hs0:
    buffer_store_dwordx4 v[192:195], v6, s[16:19], s50 offen offset:0 sc1
    buffer_store_dwordx4 v[200:203], v6, s[16:19], s51 offen offset:0 sc1
    buffer_store_dwordx4 v[208:211], v6, s[16:19], s50 offen offset:1024 sc1
    buffer_store_dwordx4 v[216:219], v6, s[16:19], s51 offen offset:1024 sc1
    s_nop 0
    s_branch L_hr0
L_hs1:
    buffer_store_dwordx4 v[196:199], v6, s[16:19], s50 offen offset:2048 sc1
    buffer_store_dwordx4 v[204:207], v6, s[16:19], s51 offen offset:2048 sc1
    buffer_store_dwordx4 v[212:215], v6, s[16:19], s50 offen offset:3072 sc1
    buffer_store_dwordx4 v[220:223], v6, s[16:19], s51 offen offset:3072 sc1
    s_nop 0
    s_branch L_hr1
L_xc:
    s_mov_b32 s53, 0x100000
L_xrc:
    s_sub_u32 s53, s53, 1
    s_cbranch_scc1 L_xoc
    buffer_load_dwordx2 v[220:221], v7, s[16:19], s55 offen sc1
    s_waitcnt vmcnt(0)
    v_cmp_eq_u32 vcc, v18, v220
    s_nop 0
    s_cmp_eq_u64 vcc, -1
    s_nop 2
    s_cbranch_scc0 L_xrc
    s_branch L_xoc
L_fs:
    buffer_store_dword v18, v17, s[16:19], s52 offen sc1
    s_branch L_fr
L_arole:
    v_and_b32 v3, 15, v1
    v_lshrrev_b32 v4, 4, v1
    s_movk_i32 s49, 1152
    s_lshl_b32 s66, s5, 4
    v_mov_b32 v7, s66
    v_mad_u32_u24 v7, v1, s49, v7
    s_mul_i32 s46, s3, 9216
    s_mov_b32 s32, s8
    s_and_b32 s33, s9, 0xffff
    s_mov_b32 s34, 0x240000
    s_mov_b32 s35, 0x00020000
    s_cmp_lt_u32 s3, 4
    s_cmp_eq_u32 s3, 7
    s_cbranch_scc1 L_a_h0
L_a_r0:
    s_waitcnt lgkmcnt(0)
    s_mov_b32 s36, s28
    s_and_b32 s37, s29, 0xffff
    s_mov_b32 s38, 0x900000
    s_mov_b32 s39, 0x00020000
    s_mov_b32 s40, s26
    s_and_b32 s41, s27, 0xffff
    s_mov_b32 s42, 0x10000000
    s_mov_b32 s43, 0x00020000
    s_cmp_eq_u32 s3, 7
    s_cbranch_scc1 L_a_c0
    s_setprio 1
    s_cmp_ge_u32 s3, 4
    s_cbranch_scc1 L_a_c0
    s_setprio 2
L_a_c0:
    v_mov_b32 v20, 0
    v_mov_b32 v21, 0
    v_mov_b32 v22, 0
    v_mov_b32 v23, 0
    s_mul_i32 s66, s3, 4096
    s_add_u32 s44, s66, 115712
    v_lshl_add_u32 v9, v1, 4, s44
    ds_write_b128 v9, v[20:23] offset:0
    ds_write_b128 v9, v[20:23] offset:1024
    ds_write_b128 v9, v[20:23] offset:2048
    ds_write_b128 v9, v[20:23] offset:3072
    v_lshlrev_b32 v9, 3, v0
    ds_write_b64 v9, v[20:21]
    s_mov_b32 s50, 11
    s_mov_b32 s51, 7
    s_cmp_eq_u32 s3, 1
    s_cselect_b32 s50, 6, s50
    s_cselect_b32 s51, 31, s51
    s_cmp_eq_u32 s3, 2
    s_cselect_b32 s50, 3, s50
    s_cselect_b32 s51, 7, s51
    s_cmp_eq_u32 s3, 3
    s_cselect_b32 s50, 6, s50
    s_cselect_b32 s51, 31, s51
    s_cmp_eq_u32 s3, 4
    s_cselect_b32 s50, 5, s50
    s_cselect_b32 s51, 127, s51
    s_cmp_eq_u32 s3, 5
    s_cselect_b32 s50, 4, s50
    s_cselect_b32 s51, 511, s51
    s_cmp_eq_u32 s3, 6
    s_cselect_b32 s50, 12, s50
    s_cselect_b32 s51, 3, s51
    s_cmp_eq_u32 s3, 7
    s_cselect_b32 s50, 12, s50
    s_cselect_b32 s51, 3, s51
    s_mov_b32 s47, 0x3f800000
    s_mov_b32 s48, 0xffff0000
    s_cmp_ge_u32 s3, 6
    s_cselect_b32 s47, s48, s47
    s_lshr_b32 s48, s47, 16
    v_lshlrev_b32 v18, 3, v4
    v_add_u32 v19, s50, v3
    v_lshlrev_b32 v19, v19, s51
    v_lshrrev_b32 v19, v18, v19
    v_bfe_i32 v24, v19, 0, 1
    v_bfe_i32 v25, v19, 1, 1
    v_and_b32 v24, s48, v24
    v_and_or_b32 v20, v25, s47, v24
    v_bfe_i32 v24, v19, 2, 1
    v_bfe_i32 v25, v19, 3, 1
    v_and_b32 v24, s48, v24
    v_and_or_b32 v21, v25, s47, v24
    v_bfe_i32 v24, v19, 4, 1
    v_bfe_i32 v25, v19, 5, 1
    v_and_b32 v24, s48, v24
    v_and_or_b32 v22, v25, s47, v24
    v_bfe_i32 v24, v19, 6, 1
    v_bfe_i32 v25, v19, 7, 1
    v_and_b32 v24, s48, v24
    v_and_or_b32 v23, v25, s47, v24
    s_cmp_eq_u32 s3, 7
    s_cselect_b32 s66, 0, -1
    v_and_b32 v20, s66, v20
    v_and_b32 v21, s66, v21
    v_and_b32 v22, s66, v22
    v_and_b32 v23, s66, v23
    s_lshl_b32 s66, s3, 10
    s_add_u32 s66, s66, 148480
    v_lshl_add_u32 v9, v1, 4, s66
    ds_write_b128 v9, v[20:23]
    s_movk_i32 s66, 528
    s_add_u32 s50, s46, 41984
    v_lshl_add_u32 v24, v4, 4, s50
    v_mad_u32_u24 v18, v3, s66, v24
    v_sub_u32 v25, 15, v3
    v_mad_u32_u24 v19, v25, s66, v24
    v_and_b32 v30, 3, v25
    v_max_u32 v30, 1, v30
    v_lshrrev_b32 v25, 2, v25
    v_lshl_add_u32 v25, v25, 1, v30
    v_add_u32 v25, -1, v25
    v_mad_u32_u24 v5, v25, s66, v24
    v_lshlrev_b32 v24, 5, v3
    v_lshlrev_b32 v25, 3, v4
    v_sub_u32 v24, v25, v24
    v_add_u32 v6, s44, v24
    v_add_u32 v6, 512, v6
    v_lshlrev_b32 v9, 2, v3
    v_lshlrev_b32 v25, 7, v4
    v_add_u32 v9, v9, v25
    v_sub_u32 v9, 3324, v9
    v_add_u32 v26, -64, v9
    v_lshlrev_b32 v30, 3, v3
    v_add_u32 v30, v30, v25
    v_sub_u32 v30, 3192, v30
    v_add_u32 v31, 4, v30
    v_cmp_gt_u32 vcc, 2, v4
    s_nop 1
    v_cndmask_b32 v9, v30, v9, vcc
    v_cndmask_b32 v26, v31, v26, vcc
    v_add_u32 v9, s44, v9
    v_add_u32 v26, s44, v26
    v_and_b32 v24, 1, v3
    v_cmp_eq_u32 vcc, 1, v24
    v_mov_b32 v24, 1214
    v_mov_b32 v25, 0
    v_cndmask_b32 v24, v24, v25, vcc
    v_lshlrev_b32 v25, 4, v4
    v_add_u32 v24, v24, v25
    v_lshlrev_b32 v25, 1, v3
    v_sub_u32 v24, v24, v25
    v_add_u32 v24, s44, v24
    v_add_u32 v8, 30, v24
    v_lshlrev_b32 v27, 5, v4
    v_lshlrev_b32 v25, 3, v3
    v_sub_u32 v27, v27, v25
    v_add_u32 v27, s44, v27
    v_add_u32 v27, 2680, v27
    v_lshlrev_b32 v28, 4, v4
    v_lshlrev_b32 v25, 2, v3
    v_sub_u32 v28, v28, v25
    v_add_u32 v28, s44, v28
    v_add_u32 v28, 3132, v28
    s_mov_b32 m0, s46
    s_waitcnt lgkmcnt(0)
    s_barrier
    s_cmp_eq_u32 s3, 7
    s_cbranch_scc1 L_a_pw
    s_waitcnt vmcnt(0)
L_a_pr:
    s_cmp_eq_u32 s3, 7
    s_cbranch_scc1 L_a_h1
L_a_r1:
    v_lshlrev_b32 v32, 16, v10
    v_and_b32 v33, 0xffff0000, v10
    v_lshlrev_b32 v34, 16, v11
    v_and_b32 v35, 0xffff0000, v11
    v_lshlrev_b32 v36, 16, v12
    v_and_b32 v37, 0xffff0000, v12
    v_lshlrev_b32 v38, 16, v13
    v_and_b32 v39, 0xffff0000, v13
    v_lshlrev_b32 v40, 16, v14
    v_and_b32 v41, 0xffff0000, v14
    v_lshlrev_b32 v42, 16, v15
    v_and_b32 v43, 0xffff0000, v15
    v_lshlrev_b32 v16, 16, v16
    v_lshlrev_b32 v17, 16, v17
    v_mul_f32 v16, 0x3fb8aa3b, v16
    v_exp_f32 v16, v16
    s_nop 0
    v_cvt_pk_bf16_f32 v16, v16, v16
    v_and_b32 v16, 0xffff0000, v16
    v_mul_f32 v32, v16, v32
    v_mul_f32 v33, v16, v33
    v_mul_f32 v34, v16, v34
    v_mul_f32 v35, v16, v35
    v_mul_f32 v36, v16, v36
    v_mul_f32 v37, v16, v37
    v_mul_f32 v38, v16, v38
    v_mul_f32 v39, v16, v39
    v_mul_f32 v32, 0x3fb8aa3b, v32
    v_mul_f32 v33, 0x3fb8aa3b, v33
    v_mul_f32 v34, 0x3e22f983, v34
    v_mul_f32 v35, 0x3e22f983, v35
    v_pk_mul_f32 v[56:57], v[40:41], v[36:37]
    v_pk_mul_f32 v[58:59], v[40:41], v[38:39]
    v_pk_fma_f32 v[56:57], v[42:43], v[38:39], v[56:57] neg_lo:[1,0,0] neg_hi:[1,0,0]
    v_pk_fma_f32 v[58:59], v[42:43], v[36:37], v[58:59]
    v_mul_f32 v24, 0x41800000, v32
    v_mul_f32 v25, 0x41800000, v34
    v_exp_f32 v24, v24
    v_fract_f32 v25, v25
    v_cos_f32 v48, v25
    v_sin_f32 v50, v25
    v_mul_f32 v48, v24, v48
    v_mul_f32 v50, v24, v50
    v_mul_f32 v24, 0x41800000, v33
    v_mul_f32 v25, 0x41800000, v35
    v_exp_f32 v24, v24
    v_fract_f32 v25, v25
    v_cos_f32 v49, v25
    v_sin_f32 v51, v25
    v_mul_f32 v49, v24, v49
    v_mul_f32 v51, v24, v51
    v_cvt_pk_bf16_f32 v244, v56, v57
    v_cvt_pk_bf16_f32 v245, -v58, -v59
    v_pk_mul_f32 v[60:61], v[56:57], v[48:49]
    v_pk_mul_f32 v[62:63], v[56:57], v[50:51]
    v_pk_fma_f32 v[60:61], v[58:59], v[50:51], v[60:61] neg_lo:[1,0,0] neg_hi:[1,0,0]
    v_pk_fma_f32 v[62:63], v[58:59], v[48:49], v[62:63]
    v_cvt_pk_bf16_f32 v246, v60, v61
    v_cvt_pk_bf16_f32 v247, -v62, -v63
    v_pk_mul_f32 v[56:57], v[60:61], v[48:49]
    v_pk_mul_f32 v[58:59], v[60:61], v[50:51]
    v_pk_fma_f32 v[56:57], v[62:63], v[50:51], v[56:57] neg_lo:[1,0,0] neg_hi:[1,0,0]
    v_pk_fma_f32 v[58:59], v[62:63], v[48:49], v[58:59]
    v_cvt_pk_bf16_f32 v248, v56, v57
    v_cvt_pk_bf16_f32 v249, -v58, -v59
    v_pk_mul_f32 v[60:61], v[56:57], v[48:49]
    v_pk_mul_f32 v[62:63], v[56:57], v[50:51]
    v_pk_fma_f32 v[60:61], v[58:59], v[50:51], v[60:61] neg_lo:[1,0,0] neg_hi:[1,0,0]
    v_pk_fma_f32 v[62:63], v[58:59], v[48:49], v[62:63]
    v_cvt_pk_bf16_f32 v250, v60, v61
    v_cvt_pk_bf16_f32 v251, -v62, -v63
    s_waitcnt lgkmcnt(0)
    ds_write_addtid_b32 v244 offset:41984
    ds_write_addtid_b32 v245 offset:42240
    ds_write_addtid_b32 v246 offset:42512
    ds_write_addtid_b32 v247 offset:42768
    ds_write_addtid_b32 v248 offset:43040
    ds_write_addtid_b32 v249 offset:43296
    ds_write_addtid_b32 v250 offset:43568
    ds_write_addtid_b32 v251 offset:43824
    v_pk_mul_f32 v[56:57], v[60:61], v[48:49]
    v_pk_mul_f32 v[58:59], v[60:61], v[50:51]
    v_pk_fma_f32 v[56:57], v[62:63], v[50:51], v[56:57] neg_lo:[1,0,0] neg_hi:[1,0,0]
    v_pk_fma_f32 v[58:59], v[62:63], v[48:49], v[58:59]
    v_cvt_pk_bf16_f32 v244, v56, v57
    v_cvt_pk_bf16_f32 v245, -v58, -v59
    ds_write_addtid_b32 v244 offset:44096
    ds_write_addtid_b32 v245 offset:44352
    v_pk_mul_f32 v[60:61], v[56:57], v[48:49]
    v_pk_mul_f32 v[62:63], v[56:57], v[50:51]
    v_pk_fma_f32 v[60:61], v[58:59], v[50:51], v[60:61] neg_lo:[1,0,0] neg_hi:[1,0,0]
    v_pk_fma_f32 v[62:63], v[58:59], v[48:49], v[62:63]
    v_cvt_pk_bf16_f32 v246, v60, v61
    v_cvt_pk_bf16_f32 v247, -v62, -v63
    ds_write_addtid_b32 v246 offset:44624
    ds_write_addtid_b32 v247 offset:44880
    v_pk_mul_f32 v[56:57], v[60:61], v[48:49]
    v_pk_mul_f32 v[58:59], v[60:61], v[50:51]
    v_pk_fma_f32 v[56:57], v[62:63], v[50:51], v[56:57] neg_lo:[1,0,0] neg_hi:[1,0,0]
    v_pk_fma_f32 v[58:59], v[62:63], v[48:49], v[58:59]
    v_cvt_pk_bf16_f32 v248, v56, v57
    v_cvt_pk_bf16_f32 v249, -v58, -v59
    ds_write_addtid_b32 v248 offset:45152
    ds_write_addtid_b32 v249 offset:45408
    v_pk_mul_f32 v[60:61], v[56:57], v[48:49]
    v_pk_mul_f32 v[62:63], v[56:57], v[50:51]
    v_pk_fma_f32 v[60:61], v[58:59], v[50:51], v[60:61] neg_lo:[1,0,0] neg_hi:[1,0,0]
    v_pk_fma_f32 v[62:63], v[58:59], v[48:49], v[62:63]
    v_cvt_pk_bf16_f32 v250, v60, v61
    v_cvt_pk_bf16_f32 v251, -v62, -v63
    ds_write_addtid_b32 v250 offset:45680
    ds_write_addtid_b32 v251 offset:45936
    v_pk_mul_f32 v[56:57], v[60:61], v[48:49]
    v_pk_mul_f32 v[58:59], v[60:61], v[50:51]
    v_pk_fma_f32 v[56:57], v[62:63], v[50:51], v[56:57] neg_lo:[1,0,0] neg_hi:[1,0,0]
    v_pk_fma_f32 v[58:59], v[62:63], v[48:49], v[58:59]
    v_cvt_pk_bf16_f32 v244, v56, v57
    v_cvt_pk_bf16_f32 v245, -v58, -v59
    ds_write_addtid_b32 v244 offset:46208
    ds_write_addtid_b32 v245 offset:46464
    s_cmp_eq_u32 s3, 7
    s_cbranch_scc1 L_a_h2
L_a_r2:
    v_pk_mul_f32 v[60:61], v[56:57], v[48:49]
    v_pk_mul_f32 v[62:63], v[56:57], v[50:51]
    v_pk_fma_f32 v[60:61], v[58:59], v[50:51], v[60:61] neg_lo:[1,0,0] neg_hi:[1,0,0]
    v_pk_fma_f32 v[62:63], v[58:59], v[48:49], v[62:63]
    v_cvt_pk_bf16_f32 v246, v60, v61
    v_cvt_pk_bf16_f32 v247, -v62, -v63
    ds_write_addtid_b32 v246 offset:46736
    ds_write_addtid_b32 v247 offset:46992
    v_pk_mul_f32 v[56:57], v[60:61], v[48:49]
    v_pk_mul_f32 v[58:59], v[60:61], v[50:51]
    v_pk_fma_f32 v[56:57], v[62:63], v[50:51], v[56:57] neg_lo:[1,0,0] neg_hi:[1,0,0]
    v_pk_fma_f32 v[58:59], v[62:63], v[48:49], v[58:59]
    v_cvt_pk_bf16_f32 v248, v56, v57
    v_cvt_pk_bf16_f32 v249, -v58, -v59
    ds_write_addtid_b32 v248 offset:47264
    ds_write_addtid_b32 v249 offset:47520
    v_pk_mul_f32 v[60:61], v[56:57], v[48:49]
    v_pk_mul_f32 v[62:63], v[56:57], v[50:51]
    v_pk_fma_f32 v[60:61], v[58:59], v[50:51], v[60:61] neg_lo:[1,0,0] neg_hi:[1,0,0]
    v_pk_fma_f32 v[62:63], v[58:59], v[48:49], v[62:63]
    v_cvt_pk_bf16_f32 v250, v60, v61
    v_cvt_pk_bf16_f32 v251, -v62, -v63
    ds_write_addtid_b32 v250 offset:47792
    ds_write_addtid_b32 v251 offset:48048
    v_pk_mul_f32 v[56:57], v[60:61], v[48:49]
    v_pk_mul_f32 v[58:59], v[60:61], v[50:51]
    v_pk_fma_f32 v[56:57], v[62:63], v[50:51], v[56:57] neg_lo:[1,0,0] neg_hi:[1,0,0]
    v_pk_fma_f32 v[58:59], v[62:63], v[48:49], v[58:59]
    v_cvt_pk_bf16_f32 v244, v56, v57
    v_cvt_pk_bf16_f32 v245, -v58, -v59
    ds_write_addtid_b32 v244 offset:48320
    ds_write_addtid_b32 v245 offset:48576
    v_pk_mul_f32 v[60:61], v[56:57], v[48:49]
    v_pk_mul_f32 v[62:63], v[56:57], v[50:51]
    v_pk_fma_f32 v[60:61], v[58:59], v[50:51], v[60:61] neg_lo:[1,0,0] neg_hi:[1,0,0]
    v_pk_fma_f32 v[62:63], v[58:59], v[48:49], v[62:63]
    v_cvt_pk_bf16_f32 v246, v60, v61
    v_cvt_pk_bf16_f32 v247, -v62, -v63
    ds_write_addtid_b32 v246 offset:48848
    ds_write_addtid_b32 v247 offset:49104
    v_pk_mul_f32 v[56:57], v[60:61], v[48:49]
    v_pk_mul_f32 v[58:59], v[60:61], v[50:51]
    v_pk_fma_f32 v[56:57], v[62:63], v[50:51], v[56:57] neg_lo:[1,0,0] neg_hi:[1,0,0]
    v_pk_fma_f32 v[58:59], v[62:63], v[48:49], v[58:59]
    v_cvt_pk_bf16_f32 v248, v56, v57
    v_cvt_pk_bf16_f32 v249, -v58, -v59
    ds_write_addtid_b32 v248 offset:49376
    ds_write_addtid_b32 v249 offset:49632
    v_pk_mul_f32 v[60:61], v[56:57], v[48:49]
    v_pk_mul_f32 v[62:63], v[56:57], v[50:51]
    v_pk_fma_f32 v[60:61], v[58:59], v[50:51], v[60:61] neg_lo:[1,0,0] neg_hi:[1,0,0]
    v_pk_fma_f32 v[62:63], v[58:59], v[48:49], v[62:63]
    v_cvt_pk_bf16_f32 v250, v60, v61
    v_cvt_pk_bf16_f32 v251, -v62, -v63
    ds_write_addtid_b32 v250 offset:49904
    ds_write_addtid_b32 v251 offset:50160
    s_cmp_eq_u32 s3, 7
    s_cbranch_scc1 L_a_h3
L_a_r3:
    s_waitcnt lgkmcnt(0)
    ds_read_b128 v[144:147], v18 offset:0
    ds_read_b128 v[148:151], v18 offset:64
    ds_read_b128 v[152:155], v18 offset:128
    ds_read_b128 v[156:159], v18 offset:192
    ds_read_b128 v[160:163], v18 offset:256
    ds_read_b128 v[164:167], v18 offset:320
    ds_read_b128 v[168:171], v18 offset:384
    ds_read_b128 v[172:175], v18 offset:448
    v_exp_f32 v24, v32
    v_fract_f32 v25, v34
    v_cos_f32 v44, v25
    v_sin_f32 v46, v25
    v_mul_f32 v44, v24, v44
    v_mul_f32 v46, v24, v46
    v_exp_f32 v24, v33
    v_fract_f32 v25, v35
    v_cos_f32 v45, v25
    v_sin_f32 v47, v25
    v_mul_f32 v45, v24, v45
    v_mul_f32 v47, v24, v47
    v_mul_f32 v24, 0x43800000, v32
    v_mul_f32 v25, 0x43800000, v34
    v_exp_f32 v24, v24
    v_fract_f32 v25, v25
    v_cos_f32 v52, v25
    v_sin_f32 v54, v25
    v_mul_f32 v52, v24, v52
    v_mul_f32 v54, v24, v54
    v_mul_f32 v24, 0x43800000, v33
    v_mul_f32 v25, 0x43800000, v35
    v_exp_f32 v24, v24
    v_fract_f32 v25, v25
    v_cos_f32 v53, v25
    v_sin_f32 v55, v25
    v_mul_f32 v53, v24, v53
    v_mul_f32 v55, v24, v55
    v_mov_b32 v60, 1.0
    v_mov_b32 v61, 1.0
    v_mov_b32 v62, 0
    v_mov_b32 v63, 0
    v_cvt_pk_bf16_f32 v244, v60, v61
    v_cvt_pk_bf16_f32 v245, v62, v63
    v_cvt_pk_bf16_f32 v246, v44, v45
    v_cvt_pk_bf16_f32 v247, v46, v47
    v_pk_mul_f32 v[176:177], v[44:45], v[44:45]
    v_pk_mul_f32 v[178:179], v[44:45], v[46:47]
    v_pk_fma_f32 v[176:177], v[46:47], v[46:47], v[176:177] neg_lo:[1,0,0] neg_hi:[1,0,0]
    v_pk_fma_f32 v[178:179], v[46:47], v[44:45], v[178:179]
    v_cvt_pk_bf16_f32 v248, v176, v177
    v_cvt_pk_bf16_f32 v249, v178, v179
    v_pk_mul_f32 v[56:57], v[176:177], v[44:45]
    v_pk_mul_f32 v[58:59], v[176:177], v[46:47]
    v_pk_fma_f32 v[56:57], v[178:179], v[46:47], v[56:57] neg_lo:[1,0,0] neg_hi:[1,0,0]
    v_pk_fma_f32 v[58:59], v[178:179], v[44:45], v[58:59]
    v_cvt_pk_bf16_f32 v250, v56, v57
    v_cvt_pk_bf16_f32 v251, v58, v59
    s_waitcnt lgkmcnt(0)
    ds_write_addtid_b32 v244 offset:41984
    ds_write_addtid_b32 v245 offset:42240
    ds_write_addtid_b32 v246 offset:42512
    ds_write_addtid_b32 v247 offset:42768
    ds_write_addtid_b32 v248 offset:43040
    ds_write_addtid_b32 v249 offset:43296
    ds_write_addtid_b32 v250 offset:43568
    ds_write_addtid_b32 v251 offset:43824
    v_pk_mul_f32 v[180:181], v[56:57], v[44:45]
    v_pk_mul_f32 v[182:183], v[56:57], v[46:47]
    v_pk_fma_f32 v[180:181], v[58:59], v[46:47], v[180:181] neg_lo:[1,0,0] neg_hi:[1,0,0]
    v_pk_fma_f32 v[182:183], v[58:59], v[44:45], v[182:183]
    v_cvt_pk_bf16_f32 v244, v180, v181
    v_cvt_pk_bf16_f32 v245, v182, v183
    ds_write_addtid_b32 v244 offset:44096
    ds_write_addtid_b32 v245 offset:44352
    v_pk_mul_f32 v[56:57], v[180:181], v[44:45]
    v_pk_mul_f32 v[58:59], v[180:181], v[46:47]
    v_pk_fma_f32 v[56:57], v[182:183], v[46:47], v[56:57] neg_lo:[1,0,0] neg_hi:[1,0,0]
    v_pk_fma_f32 v[58:59], v[182:183], v[44:45], v[58:59]
    v_cvt_pk_bf16_f32 v246, v56, v57
    v_cvt_pk_bf16_f32 v247, v58, v59
    ds_write_addtid_b32 v246 offset:44624
    ds_write_addtid_b32 v247 offset:44880
    v_pk_mul_f32 v[184:185], v[56:57], v[44:45]
    v_pk_mul_f32 v[186:187], v[56:57], v[46:47]
    v_pk_fma_f32 v[184:185], v[58:59], v[46:47], v[184:185] neg_lo:[1,0,0] neg_hi:[1,0,0]
    v_pk_fma_f32 v[186:187], v[58:59], v[44:45], v[186:187]
    v_cvt_pk_bf16_f32 v248, v184, v185
    v_cvt_pk_bf16_f32 v249, v186, v187
    ds_write_addtid_b32 v248 offset:45152
    ds_write_addtid_b32 v249 offset:45408
    v_pk_mul_f32 v[56:57], v[184:185], v[44:45]
    v_pk_mul_f32 v[58:59], v[184:185], v[46:47]
    v_pk_fma_f32 v[56:57], v[186:187], v[46:47], v[56:57] neg_lo:[1,0,0] neg_hi:[1,0,0]
    v_pk_fma_f32 v[58:59], v[186:187], v[44:45], v[58:59]
    v_cvt_pk_bf16_f32 v250, v56, v57
    v_cvt_pk_bf16_f32 v251, v58, v59
    ds_write_addtid_b32 v250 offset:45680
    ds_write_addtid_b32 v251 offset:45936
    v_pk_mul_f32 v[188:189], v[56:57], v[44:45]
    v_pk_mul_f32 v[190:191], v[56:57], v[46:47]
    v_pk_fma_f32 v[188:189], v[58:59], v[46:47], v[188:189] neg_lo:[1,0,0] neg_hi:[1,0,0]
    v_pk_fma_f32 v[190:191], v[58:59], v[44:45], v[190:191]
    v_cvt_pk_bf16_f32 v244, v188, v189
    v_cvt_pk_bf16_f32 v245, v190, v191
    ds_write_addtid_b32 v244 offset:46208
    ds_write_addtid_b32 v245 offset:46464
    s_cmp_eq_u32 s3, 7
    s_cbranch_scc1 L_a_h4
L_a_r4:
    v_pk_mul_f32 v[56:57], v[188:189], v[44:45]
    v_pk_mul_f32 v[58:59], v[188:189], v[46:47]
    v_pk_fma_f32 v[56:57], v[190:191], v[46:47], v[56:57] neg_lo:[1,0,0] neg_hi:[1,0,0]
    v_pk_fma_f32 v[58:59], v[190:191], v[44:45], v[58:59]
    v_cvt_pk_bf16_f32 v246, v56, v57
    v_cvt_pk_bf16_f32 v247, v58, v59
    ds_write_addtid_b32 v246 offset:46736
    ds_write_addtid_b32 v247 offset:46992
    v_pk_mul_f32 v[192:193], v[56:57], v[44:45]
    v_pk_mul_f32 v[194:195], v[56:57], v[46:47]
    v_pk_fma_f32 v[192:193], v[58:59], v[46:47], v[192:193] neg_lo:[1,0,0] neg_hi:[1,0,0]
    v_pk_fma_f32 v[194:195], v[58:59], v[44:45], v[194:195]
    v_cvt_pk_bf16_f32 v248, v192, v193
    v_cvt_pk_bf16_f32 v249, v194, v195
    ds_write_addtid_b32 v248 offset:47264
    ds_write_addtid_b32 v249 offset:47520
    v_pk_mul_f32 v[56:57], v[192:193], v[44:45]
    v_pk_mul_f32 v[58:59], v[192:193], v[46:47]
    v_pk_fma_f32 v[56:57], v[194:195], v[46:47], v[56:57] neg_lo:[1,0,0] neg_hi:[1,0,0]
    v_pk_fma_f32 v[58:59], v[194:195], v[44:45], v[58:59]
    v_cvt_pk_bf16_f32 v250, v56, v57
    v_cvt_pk_bf16_f32 v251, v58, v59
    ds_write_addtid_b32 v250 offset:47792
    ds_write_addtid_b32 v251 offset:48048
    v_pk_mul_f32 v[196:197], v[56:57], v[44:45]
    v_pk_mul_f32 v[198:199], v[56:57], v[46:47]
    v_pk_fma_f32 v[196:197], v[58:59], v[46:47], v[196:197] neg_lo:[1,0,0] neg_hi:[1,0,0]
    v_pk_fma_f32 v[198:199], v[58:59], v[44:45], v[198:199]
    v_cvt_pk_bf16_f32 v244, v196, v197
    v_cvt_pk_bf16_f32 v245, v198, v199
    ds_write_addtid_b32 v244 offset:48320
    ds_write_addtid_b32 v245 offset:48576
    v_pk_mul_f32 v[56:57], v[196:197], v[44:45]
    v_pk_mul_f32 v[58:59], v[196:197], v[46:47]
    v_pk_fma_f32 v[56:57], v[198:199], v[46:47], v[56:57] neg_lo:[1,0,0] neg_hi:[1,0,0]
    v_pk_fma_f32 v[58:59], v[198:199], v[44:45], v[58:59]
    v_cvt_pk_bf16_f32 v246, v56, v57
    v_cvt_pk_bf16_f32 v247, v58, v59
    ds_write_addtid_b32 v246 offset:48848
    ds_write_addtid_b32 v247 offset:49104
    v_pk_mul_f32 v[200:201], v[56:57], v[44:45]
    v_pk_mul_f32 v[202:203], v[56:57], v[46:47]
    v_pk_fma_f32 v[200:201], v[58:59], v[46:47], v[200:201] neg_lo:[1,0,0] neg_hi:[1,0,0]
    v_pk_fma_f32 v[202:203], v[58:59], v[44:45], v[202:203]
    v_cvt_pk_bf16_f32 v248, v200, v201
    v_cvt_pk_bf16_f32 v249, v202, v203
    ds_write_addtid_b32 v248 offset:49376
    ds_write_addtid_b32 v249 offset:49632
    v_pk_mul_f32 v[56:57], v[200:201], v[44:45]
    v_pk_mul_f32 v[58:59], v[200:201], v[46:47]
    v_pk_fma_f32 v[56:57], v[202:203], v[46:47], v[56:57] neg_lo:[1,0,0] neg_hi:[1,0,0]
    v_pk_fma_f32 v[58:59], v[202:203], v[44:45], v[58:59]
    v_cvt_pk_bf16_f32 v250, v56, v57
    v_cvt_pk_bf16_f32 v251, v58, v59
    ds_write_addtid_b32 v250 offset:49904
    ds_write_addtid_b32 v251 offset:50160
    s_cmp_eq_u32 s3, 7
    s_cbranch_scc1 L_a_h5
L_a_r5:
    s_waitcnt lgkmcnt(0)
    ds_read_b128 v[212:215], v19 offset:0
    ds_read_b128 v[216:219], v19 offset:64
    ds_read_b128 v[220:223], v19 offset:128
    ds_read_b128 v[224:227], v19 offset:192
    ds_read_b128 v[228:231], v19 offset:256
    ds_read_b128 v[232:235], v19 offset:320
    ds_read_b128 v[236:239], v19 offset:384
    ds_read_b128 v[240:243], v19 offset:448
    v_cvt_pk_bf16_f32 v244, v52, v53
    v_cvt_pk_bf16_f32 v245, v54, v55
    s_waitcnt lgkmcnt(7)
    v_mfma_f32_16x16x32_bf16 v[132:135], v[212:215], v[144:147], 0
    s_waitcnt lgkmcnt(6)
    v_mfma_f32_16x16x32_bf16 v[132:135], v[216:219], v[148:151], v[132:135]
    v_mul_f32 v60, v52, v176
    v_mul_f32 v62, v52, v178
    v_mul_f32 v61, v53, v177
    v_mul_f32 v63, v53, v179
    v_fma_f32 v60, -v54, v178, v60
    v_fmac_f32 v62, v54, v176
    v_fma_f32 v61, -v55, v179, v61
    v_fmac_f32 v63, v55, v177
    v_cvt_pk_bf16_f32 v246, v60, v61
    v_cvt_pk_bf16_f32 v247, v62, v63
    s_waitcnt lgkmcnt(5)
    v_mfma_f32_16x16x32_bf16 v[132:135], v[220:223], v[152:155], v[132:135]
    s_waitcnt lgkmcnt(4)
    v_mfma_f32_16x16x32_bf16 v[132:135], v[224:227], v[156:159], v[132:135]
    v_mul_f32 v56, v52, v180
    v_mul_f32 v58, v52, v182
    v_mul_f32 v57, v53, v181
    v_mul_f32 v59, v53, v183
    v_fma_f32 v56, -v54, v182, v56
    v_fmac_f32 v58, v54, v180
    v_fma_f32 v57, -v55, v183, v57
    v_fmac_f32 v59, v55, v181
    v_cvt_pk_bf16_f32 v248, v56, v57
    v_cvt_pk_bf16_f32 v249, v58, v59
    s_waitcnt lgkmcnt(3)
    v_mfma_f32_16x16x32_bf16 v[132:135], v[228:231], v[160:163], v[132:135]
    s_waitcnt lgkmcnt(2)
    v_mfma_f32_16x16x32_bf16 v[132:135], v[232:235], v[164:167], v[132:135]
    v_mul_f32 v60, v52, v184
    v_mul_f32 v62, v52, v186
    v_mul_f32 v61, v53, v185
    v_mul_f32 v63, v53, v187
    v_fma_f32 v60, -v54, v186, v60
    v_fmac_f32 v62, v54, v184
    v_fma_f32 v61, -v55, v187, v61
    v_fmac_f32 v63, v55, v185
    v_cvt_pk_bf16_f32 v250, v60, v61
    v_cvt_pk_bf16_f32 v251, v62, v63
    s_waitcnt lgkmcnt(1)
    v_mfma_f32_16x16x32_bf16 v[132:135], v[236:239], v[168:171], v[132:135]
    s_waitcnt lgkmcnt(0)
    v_mfma_f32_16x16x32_bf16 v[132:135], v[240:243], v[172:175], v[132:135]
    ds_write_addtid_b32 v244 offset:41984
    ds_write_addtid_b32 v245 offset:42240
    ds_write_addtid_b32 v246 offset:42512
    ds_write_addtid_b32 v247 offset:42768
    ds_write_addtid_b32 v248 offset:43040
    ds_write_addtid_b32 v249 offset:43296
    ds_write_addtid_b32 v250 offset:43568
    ds_write_addtid_b32 v251 offset:43824
    v_mul_f32 v56, v52, v188
    v_mul_f32 v58, v52, v190
    v_mul_f32 v57, v53, v189
    v_mul_f32 v59, v53, v191
    v_fma_f32 v56, -v54, v190, v56
    v_fmac_f32 v58, v54, v188
    v_fma_f32 v57, -v55, v191, v57
    v_fmac_f32 v59, v55, v189
    v_cvt_pk_bf16_f32 v244, v56, v57
    v_cvt_pk_bf16_f32 v245, v58, v59
    ds_write_addtid_b32 v244 offset:44096
    ds_write_addtid_b32 v245 offset:44352
    v_mul_f32 v60, v52, v192
    v_mul_f32 v62, v52, v194
    v_mul_f32 v61, v53, v193
    v_mul_f32 v63, v53, v195
    v_fma_f32 v60, -v54, v194, v60
    v_fmac_f32 v62, v54, v192
    v_fma_f32 v61, -v55, v195, v61
    v_fmac_f32 v63, v55, v193
    v_cvt_pk_bf16_f32 v246, v60, v61
    v_cvt_pk_bf16_f32 v247, v62, v63
    ds_write_addtid_b32 v246 offset:44624
    ds_write_addtid_b32 v247 offset:44880
    v_mul_f32 v56, v52, v196
    v_mul_f32 v58, v52, v198
    v_mul_f32 v57, v53, v197
    v_mul_f32 v59, v53, v199
    v_fma_f32 v56, -v54, v198, v56
    v_fmac_f32 v58, v54, v196
    v_fma_f32 v57, -v55, v199, v57
    v_fmac_f32 v59, v55, v197
    v_cvt_pk_bf16_f32 v248, v56, v57
    v_cvt_pk_bf16_f32 v249, v58, v59
    ds_write_addtid_b32 v248 offset:45152
    ds_write_addtid_b32 v249 offset:45408
    v_mul_f32 v60, v52, v200
    v_mul_f32 v62, v52, v202
    v_mul_f32 v61, v53, v201
    v_mul_f32 v63, v53, v203
    v_fma_f32 v60, -v54, v202, v60
    v_fmac_f32 v62, v54, v200
    v_fma_f32 v61, -v55, v203, v61
    v_fmac_f32 v63, v55, v201
    v_cvt_pk_bf16_f32 v250, v60, v61
    v_cvt_pk_bf16_f32 v251, v62, v63
    ds_write_addtid_b32 v250 offset:45680
    ds_write_addtid_b32 v251 offset:45936
    v_mul_f32 v56, v52, v48
    v_mul_f32 v58, v52, v50
    v_mul_f32 v57, v53, v49
    v_mul_f32 v59, v53, v51
    v_fma_f32 v56, -v54, v50, v56
    v_fmac_f32 v58, v54, v48
    v_fma_f32 v57, -v55, v51, v57
    v_fmac_f32 v59, v55, v49
    v_cvt_pk_bf16_f32 v244, v56, v57
    v_cvt_pk_bf16_f32 v245, v58, v59
    ds_write_addtid_b32 v244 offset:46208
    ds_write_addtid_b32 v245 offset:46464
    s_waitcnt lgkmcnt(0)
    ds_read_b128 v[212:215], v5 offset:0
    ds_read_b128 v[216:219], v5 offset:64
    ds_read_b128 v[220:223], v5 offset:128
    ds_read_b128 v[224:227], v5 offset:192
    ds_read_b128 v[228:231], v5 offset:256
    ds_read_b128 v[232:235], v5 offset:320
    ds_read_b128 v[236:239], v5 offset:384
    ds_read_b128 v[240:243], v5 offset:448
    v_mul_f32 v204, v52, v52
    v_mul_f32 v206, v52, v54
    v_mul_f32 v205, v53, v53
    v_mul_f32 v207, v53, v55
    v_fma_f32 v204, -v54, v54, v204
    v_fmac_f32 v206, v54, v52
    v_fma_f32 v205, -v55, v55, v205
    v_fmac_f32 v207, v55, v53
    v_mul_f32 v208, v204, v52
    v_mul_f32 v210, v204, v54
    v_mul_f32 v209, v205, v53
    v_mul_f32 v211, v205, v55
    v_fma_f32 v208, -v206, v54, v208
    v_fmac_f32 v210, v206, v52
    v_fma_f32 v209, -v207, v55, v209
    v_fmac_f32 v211, v207, v53
    v_mul_f32 v36, v204, v204
    v_mul_f32 v38, v204, v206
    v_mul_f32 v37, v205, v205
    v_mul_f32 v39, v205, v207
    v_fma_f32 v36, -v206, v206, v36
    v_fmac_f32 v38, v206, v204
    v_fma_f32 v37, -v207, v207, v37
    v_fmac_f32 v39, v207, v205
    v_mul_f32 v40, v36, v52
    v_mul_f32 v42, v36, v54
    v_mul_f32 v41, v37, v53
    v_mul_f32 v43, v37, v55
    v_fma_f32 v40, -v38, v54, v40
    v_fmac_f32 v42, v38, v52
    v_fma_f32 v41, -v39, v55, v41
    v_fmac_f32 v43, v39, v53
    v_mul_f32 v32, v36, v204
    v_mul_f32 v34, v36, v206
    v_mul_f32 v33, v37, v205
    v_mul_f32 v35, v37, v207
    v_fma_f32 v32, -v38, v206, v32
    v_fmac_f32 v34, v38, v204
    v_fma_f32 v33, -v39, v207, v33
    v_fmac_f32 v35, v39, v205
    v_mul_f32 v44, v36, v208
    v_mul_f32 v46, v36, v210
    v_mul_f32 v45, v37, v209
    v_mul_f32 v47, v37, v211
    v_fma_f32 v44, -v38, v210, v44
    v_fmac_f32 v46, v38, v208
    v_fma_f32 v45, -v39, v211, v45
    v_fmac_f32 v47, v39, v209
    v_mul_f32 v56, v36, v48
    v_mul_f32 v58, v36, v50
    v_mul_f32 v57, v37, v49
    v_mul_f32 v59, v37, v51
    v_fma_f32 v56, -v38, v50, v56
    v_fmac_f32 v58, v38, v48
    v_fma_f32 v57, -v39, v51, v57
    v_fmac_f32 v59, v39, v49
    v_cvt_pk_bf16_f32 v244, v56, v57
    v_cvt_pk_bf16_f32 v245, v58, v59
    s_waitcnt lgkmcnt(7)
    v_mfma_f32_16x16x32_bf16 v[136:139], v[212:215], v[144:147], 0
    s_waitcnt lgkmcnt(6)
    v_mfma_f32_16x16x32_bf16 v[136:139], v[216:219], v[148:151], v[136:139]
    v_mul_f32 v60, v36, v188
    v_mul_f32 v62, v36, v190
    v_mul_f32 v61, v37, v189
    v_mul_f32 v63, v37, v191
    v_fma_f32 v60, -v38, v190, v60
    v_fmac_f32 v62, v38, v188
    v_fma_f32 v61, -v39, v191, v61
    v_fmac_f32 v63, v39, v189
    v_cvt_pk_bf16_f32 v246, v60, v61
    v_cvt_pk_bf16_f32 v247, v62, v63
    s_waitcnt lgkmcnt(5)
    v_mfma_f32_16x16x32_bf16 v[136:139], v[220:223], v[152:155], v[136:139]
    s_waitcnt lgkmcnt(4)
    v_mfma_f32_16x16x32_bf16 v[136:139], v[224:227], v[156:159], v[136:139]
    v_mul_f32 v56, v40, v48
    v_mul_f32 v58, v40, v50
    v_mul_f32 v57, v41, v49
    v_mul_f32 v59, v41, v51
    v_fma_f32 v56, -v42, v50, v56
    v_fmac_f32 v58, v42, v48
    v_fma_f32 v57, -v43, v51, v57
    v_fmac_f32 v59, v43, v49
    v_cvt_pk_bf16_f32 v248, v56, v57
    v_cvt_pk_bf16_f32 v249, v58, v59
    s_waitcnt lgkmcnt(3)
    v_mfma_f32_16x16x32_bf16 v[136:139], v[228:231], v[160:163], v[136:139]
    s_waitcnt lgkmcnt(2)
    v_mfma_f32_16x16x32_bf16 v[136:139], v[232:235], v[164:167], v[136:139]
    v_mul_f32 v60, v40, v188
    v_mul_f32 v62, v40, v190
    v_mul_f32 v61, v41, v189
    v_mul_f32 v63, v41, v191
    v_fma_f32 v60, -v42, v190, v60
    v_fmac_f32 v62, v42, v188
    v_fma_f32 v61, -v43, v191, v61
    v_fmac_f32 v63, v43, v189
    v_cvt_pk_bf16_f32 v250, v60, v61
    v_cvt_pk_bf16_f32 v251, v62, v63
    s_waitcnt lgkmcnt(1)
    v_mfma_f32_16x16x32_bf16 v[136:139], v[236:239], v[168:171], v[136:139]
    s_waitcnt lgkmcnt(0)
    v_mfma_f32_16x16x32_bf16 v[136:139], v[240:243], v[172:175], v[136:139]
    ds_write_addtid_b32 v244 offset:41984
    ds_write_addtid_b32 v245 offset:42240
    ds_write_addtid_b32 v246 offset:42512
    ds_write_addtid_b32 v247 offset:42768
    ds_write_addtid_b32 v248 offset:43040
    ds_write_addtid_b32 v249 offset:43296
    ds_write_addtid_b32 v250 offset:43568
    ds_write_addtid_b32 v251 offset:43824
    v_mul_f32 v56, v32, v48
    v_mul_f32 v58, v32, v50
    v_mul_f32 v57, v33, v49
    v_mul_f32 v59, v33, v51
    v_fma_f32 v56, -v34, v50, v56
    v_fmac_f32 v58, v34, v48
    v_fma_f32 v57, -v35, v51, v57
    v_fmac_f32 v59, v35, v49
    v_cvt_pk_bf16_f32 v244, v56, v57
    v_cvt_pk_bf16_f32 v245, v58, v59
    ds_write_addtid_b32 v244 offset:44096
    ds_write_addtid_b32 v245 offset:44352
    v_mul_f32 v60, v32, v188
    v_mul_f32 v62, v32, v190
    v_mul_f32 v61, v33, v189
    v_mul_f32 v63, v33, v191
    v_fma_f32 v60, -v34, v190, v60
    v_fmac_f32 v62, v34, v188
    v_fma_f32 v61, -v35, v191, v61
    v_fmac_f32 v63, v35, v189
    v_cvt_pk_bf16_f32 v246, v60, v61
    v_cvt_pk_bf16_f32 v247, v62, v63
    ds_write_addtid_b32 v246 offset:44624
    ds_write_addtid_b32 v247 offset:44880
    v_mul_f32 v56, v44, v48
    v_mul_f32 v58, v44, v50
    v_mul_f32 v57, v45, v49
    v_mul_f32 v59, v45, v51
    v_fma_f32 v56, -v46, v50, v56
    v_fmac_f32 v58, v46, v48
    v_fma_f32 v57, -v47, v51, v57
    v_fmac_f32 v59, v47, v49
    v_cvt_pk_bf16_f32 v248, v56, v57
    v_cvt_pk_bf16_f32 v249, v58, v59
    ds_write_addtid_b32 v248 offset:45152
    ds_write_addtid_b32 v249 offset:45408
    v_mul_f32 v60, v44, v188
    v_mul_f32 v62, v44, v190
    v_mul_f32 v61, v45, v189
    v_mul_f32 v63, v45, v191
    v_fma_f32 v60, -v46, v190, v60
    v_fmac_f32 v62, v46, v188
    v_fma_f32 v61, -v47, v191, v61
    v_fmac_f32 v63, v47, v189
    v_cvt_pk_bf16_f32 v250, v60, v61
    v_cvt_pk_bf16_f32 v251, v62, v63
    ds_write_addtid_b32 v250 offset:45680
    ds_write_addtid_b32 v251 offset:45936
    v_mul_f32 v56, v204, v48
    v_mul_f32 v58, v204, v50
    v_mul_f32 v57, v205, v49
    v_mul_f32 v59, v205, v51
    v_fma_f32 v56, -v206, v50, v56
    v_fmac_f32 v58, v206, v48
    v_fma_f32 v57, -v207, v51, v57
    v_fmac_f32 v59, v207, v49
    v_cvt_pk_bf16_f32 v244, v56, v57
    v_cvt_pk_bf16_f32 v245, v58, v59
    ds_write_addtid_b32 v244 offset:46208
    ds_write_addtid_b32 v245 offset:46464
    v_mul_f32 v60, v204, v196
    v_mul_f32 v62, v204, v198
    v_mul_f32 v61, v205, v197
    v_mul_f32 v63, v205, v199
    v_fma_f32 v60, -v206, v198, v60
    v_fmac_f32 v62, v206, v196
    v_fma_f32 v61, -v207, v199, v61
    v_fmac_f32 v63, v207, v197
    v_cvt_pk_bf16_f32 v246, v60, v61
    v_cvt_pk_bf16_f32 v247, v62, v63
    ds_write_addtid_b32 v246 offset:46736
    ds_write_addtid_b32 v247 offset:46992
    v_mul_f32 v56, v204, v188
    v_mul_f32 v58, v204, v190
    v_mul_f32 v57, v205, v189
    v_mul_f32 v59, v205, v191
    v_fma_f32 v56, -v206, v190, v56
    v_fmac_f32 v58, v206, v188
    v_fma_f32 v57, -v207, v191, v57
    v_fmac_f32 v59, v207, v189
    v_cvt_pk_bf16_f32 v248, v56, v57
    v_cvt_pk_bf16_f32 v249, v58, v59
    ds_write_addtid_b32 v248 offset:47264
    ds_write_addtid_b32 v249 offset:47520
    v_mul_f32 v60, v204, v180
    v_mul_f32 v62, v204, v182
    v_mul_f32 v61, v205, v181
    v_mul_f32 v63, v205, v183
    v_fma_f32 v60, -v206, v182, v60
    v_fmac_f32 v62, v206, v180
    v_fma_f32 v61, -v207, v183, v61
    v_fmac_f32 v63, v207, v181
    v_cvt_pk_bf16_f32 v250, v60, v61
    v_cvt_pk_bf16_f32 v251, v62, v63
    ds_write_addtid_b32 v250 offset:47792
    ds_write_addtid_b32 v251 offset:48048
    v_mul_f32 v56, v208, v48
    v_mul_f32 v58, v208, v50
    v_mul_f32 v57, v209, v49
    v_mul_f32 v59, v209, v51
    v_fma_f32 v56, -v210, v50, v56
    v_fmac_f32 v58, v210, v48
    v_fma_f32 v57, -v211, v51, v57
    v_fmac_f32 v59, v211, v49
    v_cvt_pk_bf16_f32 v244, v56, v57
    v_cvt_pk_bf16_f32 v245, v58, v59
    ds_write_addtid_b32 v244 offset:48320
    ds_write_addtid_b32 v245 offset:48576
    v_mul_f32 v60, v208, v196
    v_mul_f32 v62, v208, v198
    v_mul_f32 v61, v209, v197
    v_mul_f32 v63, v209, v199
    v_fma_f32 v60, -v210, v198, v60
    v_fmac_f32 v62, v210, v196
    v_fma_f32 v61, -v211, v199, v61
    v_fmac_f32 v63, v211, v197
    v_cvt_pk_bf16_f32 v246, v60, v61
    v_cvt_pk_bf16_f32 v247, v62, v63
    ds_write_addtid_b32 v246 offset:48848
    ds_write_addtid_b32 v247 offset:49104
    v_mul_f32 v56, v208, v188
    v_mul_f32 v58, v208, v190
    v_mul_f32 v57, v209, v189
    v_mul_f32 v59, v209, v191
    v_fma_f32 v56, -v210, v190, v56
    v_fmac_f32 v58, v210, v188
    v_fma_f32 v57, -v211, v191, v57
    v_fmac_f32 v59, v211, v189
    v_cvt_pk_bf16_f32 v248, v56, v57
    v_cvt_pk_bf16_f32 v249, v58, v59
    ds_write_addtid_b32 v248 offset:49376
    ds_write_addtid_b32 v249 offset:49632
    v_mul_f32 v60, v208, v180
    v_mul_f32 v62, v208, v182
    v_mul_f32 v61, v209, v181
    v_mul_f32 v63, v209, v183
    v_fma_f32 v60, -v210, v182, v60
    v_fmac_f32 v62, v210, v180
    v_fma_f32 v61, -v211, v183, v61
    v_fmac_f32 v63, v211, v181
    v_cvt_pk_bf16_f32 v250, v60, v61
    v_cvt_pk_bf16_f32 v251, v62, v63
    ds_write_addtid_b32 v250 offset:49904
    ds_write_addtid_b32 v251 offset:50160
    v_cmp_eq_u32 vcc, 48, v1
    s_nop 1
    v_cndmask_b32 v17, 0, v17, vcc
    v_add_f32 v135, v135, v17
    v_cvt_pk_bf16_f32 v24, v132, v133
    v_cvt_pk_bf16_f32 v25, v134, v135
    v_cvt_pk_bf16_f32 v31, v133, v134
    ds_write_b64 v6, v[24:25] offset:544
    ds_write_b16 v6, v24 offset:1758
    ds_write_b32 v6, v31 offset:1760
    ds_write_b16_d16_hi v6, v25 offset:1764
    v_cvt_pk_bf16_f32 v24, v136, v137
    v_cvt_pk_bf16_f32 v25, v138, v139
    v_cvt_pk_bf16_f32 v31, v137, v138
    ds_write_b64 v6, v[24:25] offset:32
    ds_write_b16 v6, v24 offset:1246
    ds_write_b32 v6, v31 offset:1248
    ds_write_b16_d16_hi v6, v25 offset:1252
    v_cvt_pk_bf16_f32 v24, v136, v136
    v_mov_b32 v29, s44
    s_mov_b64 exec, 0x8000
    ds_write_b16 v29, v24 offset:58
    ds_write_b32 v29, v24 offset:60
    ds_write_b32 v29, v24 offset:1272
    ds_write_b16 v29, v24 offset:1276
    s_mov_b64 exec, -1
    s_waitcnt lgkmcnt(0)
    ds_read_b128 v[212:215], v18 offset:0
    ds_read_b128 v[216:219], v18 offset:64
    ds_read_b128 v[220:223], v18 offset:128
    ds_read_b128 v[224:227], v18 offset:192
    ds_read_b128 v[228:231], v18 offset:256
    ds_read_b128 v[232:235], v18 offset:320
    ds_read_b128 v[236:239], v18 offset:384
    ds_read_b128 v[240:243], v18 offset:448
    v_add_u32 v30, 512, v8
    ds_read2_b32 v[64:65], v30 offset0:128 offset1:129
    ds_read2_b32 v[66:67], v30 offset0:130 offset1:131
    ds_read2_b32 v[68:69], v30 offset0:112 offset1:113
    ds_read2_b32 v[70:71], v30 offset0:114 offset1:115
    ds_read2_b32 v[72:73], v30 offset0:96 offset1:97
    ds_read2_b32 v[74:75], v30 offset0:98 offset1:99
    s_waitcnt lgkmcnt(6)
    v_mfma_f32_16x16x32_bf16 v[140:143], v[212:215], v[144:147], 0
    ds_read2_b32 v[76:77], v30 offset0:80 offset1:81
    ds_read2_b32 v[78:79], v30 offset0:82 offset1:83
    v_mfma_f32_16x16x32_bf16 v[140:143], v[216:219], v[148:151], v[140:143]
    ds_read2_b32 v[80:81], v30 offset0:64 offset1:65
    ds_read2_b32 v[82:83], v30 offset0:66 offset1:67
    v_mfma_f32_16x16x32_bf16 v[140:143], v[220:223], v[152:155], v[140:143]
    ds_read2_b32 v[84:85], v30 offset0:48 offset1:49
    ds_read2_b32 v[86:87], v30 offset0:50 offset1:51
    v_mfma_f32_16x16x32_bf16 v[140:143], v[224:227], v[156:159], v[140:143]
    ds_read2_b32 v[88:89], v30 offset0:32 offset1:33
    ds_read2_b32 v[90:91], v30 offset0:34 offset1:35
    v_mfma_f32_16x16x32_bf16 v[140:143], v[228:231], v[160:163], v[140:143]
    ds_read2_b32 v[92:93], v30 offset0:16 offset1:17
    ds_read2_b32 v[94:95], v30 offset0:18 offset1:19
    v_mfma_f32_16x16x32_bf16 v[140:143], v[232:235], v[164:167], v[140:143]
    ds_read2_b32 v[96:97], v30 offset0:0 offset1:1
    ds_read2_b32 v[98:99], v30 offset0:2 offset1:3
    v_mfma_f32_16x16x32_bf16 v[140:143], v[236:239], v[168:171], v[140:143]
    ds_read2_b32 v[100:101], v8 offset0:112 offset1:113
    ds_read2_b32 v[102:103], v8 offset0:114 offset1:115
    v_mfma_f32_16x16x32_bf16 v[140:143], v[240:243], v[172:175], v[140:143]
    ds_read2_b32 v[104:105], v8 offset0:96 offset1:97
    ds_read2_b32 v[106:107], v8 offset0:98 offset1:99
    ds_read2_b32 v[108:109], v8 offset0:80 offset1:81
    ds_read2_b32 v[110:111], v8 offset0:82 offset1:83
    ds_read2_b32 v[112:113], v8 offset0:64 offset1:65
    ds_read2_b32 v[114:115], v8 offset0:66 offset1:67
    ds_read2_b32 v[116:117], v8 offset0:48 offset1:49
    ds_read2_b32 v[118:119], v8 offset0:50 offset1:51
    v_cvt_pk_bf16_f32 v24, v140, v141
    v_cvt_pk_bf16_f32 v25, v142, v143
    ds_write_b32 v9, v24
    ds_write_b32 v26, v25
    ds_read2_b32 v[120:121], v8 offset0:32 offset1:33
    ds_read2_b32 v[122:123], v8 offset0:34 offset1:35
    ds_read2_b32 v[124:125], v8 offset0:16 offset1:17
    ds_read2_b32 v[126:127], v8 offset0:18 offset1:19
    ds_read2_b32 v[128:129], v8 offset0:0 offset1:1
    ds_read2_b32 v[130:131], v8 offset0:2 offset1:3
    v_lshl_add_u32 v24, v3, 1, v4
    v_lshlrev_b32 v24, 7, v24
    v_lshrrev_b32 v25, 1, v4
    v_add3_u32 v25, v25, v3, 1
    v_add_u32 v31, 0, v25
    v_and_b32 v31, 7, v31
    v_xor_b32 v31, s3, v31
    v_lshl_add_u32 v10, v31, 4, v24
    v_add_u32 v31, 2, v25
    v_and_b32 v31, 7, v31
    v_xor_b32 v31, s3, v31
    v_lshl_add_u32 v11, v31, 4, v24
    v_add_u32 v31, 4, v25
    v_and_b32 v31, 7, v31
    v_xor_b32 v31, s3, v31
    v_lshl_add_u32 v12, v31, 4, v24
    v_add_u32 v31, 6, v25
    v_and_b32 v31, 7, v31
    v_xor_b32 v31, s3, v31
    v_lshl_add_u32 v13, v31, 4, v24
    v_add_u32 v25, 1, v4
    v_lshrrev_b32 v25, 1, v25
    v_add3_u32 v25, v25, v3, 6
    v_and_b32 v25, 7, v25
    v_xor_b32 v25, s3, v25
    v_lshl_add_u32 v14, v25, 4, v24
    v_lshrrev_b32 v25, 1, v4
    v_lshl_add_u32 v25, v3, 1, v25
    v_lshlrev_b32 v25, 7, v25
    v_and_b32 v31, 7, v3
    v_xor_b32 v31, s3, v31
    v_lshl_add_u32 v25, v31, 4, v25
    v_and_b32 v31, 1, v4
    v_lshl_add_u32 v15, v31, 3, v25
    v_add_u32 v15, 36864, v15
    s_lshl_b32 s66, s3, 2
    s_add_u32 s66, s66, 155680
    v_mov_b32 v16, s66
    ds_read_b64 v[152:153], v27 offset:256
    ds_read_b64 v[154:155], v27 offset:264
    ds_read_b64 v[156:157], v27 offset:272
    ds_read_b64 v[158:159], v27 offset:280
    ds_read_b64 v[160:161], v27 offset:128
    ds_read_b64 v[162:163], v27 offset:136
    ds_read_b64 v[164:165], v27 offset:144
    ds_read_b64 v[166:167], v27 offset:152
    ds_read_b64 v[168:169], v27 offset:0
    ds_read_b64 v[170:171], v27 offset:8
    ds_read_b64 v[172:173], v27 offset:16
    ds_read_b64 v[174:175], v27 offset:24
    ds_read2_b32 v[136:137], v28 offset0:48 offset1:49
    ds_read2_b32 v[138:139], v28 offset0:50 offset1:51
    ds_read2_b32 v[140:141], v28 offset0:32 offset1:33
    ds_read2_b32 v[142:143], v28 offset0:34 offset1:35
    ds_read2_b32 v[144:145], v28 offset0:16 offset1:17
    ds_read2_b32 v[146:147], v28 offset0:18 offset1:19
    ds_read2_b32 v[148:149], v28 offset0:0 offset1:1
    ds_read2_b32 v[150:151], v28 offset0:2 offset1:3
    ds_read_u16 v29, v29 offset:2688
    v_mov_b32 v30, 155648
    s_cmp_ge_u32 s3, 4
    s_cbranch_scc1 L_a_nt
    v_lshrrev_b32 v24, 4, v1
    v_bfe_u32 v20, v1, 1, 1
    v_lshl_add_u32 v20, v24, 1, v20
    v_lshlrev_b32 v20, 7, v20
    v_bfe_u32 v21, v1, 2, 2
    v_lshl_add_u32 v20, v21, 4, v20
    v_and_b32 v21, 1, v1
    v_lshl_add_u32 v20, v21, 3, v20
    v_and_b32 v21, 7, v1
    v_xor_b32 v21, v21, v24
    v_lshlrev_b32 v21, 4, v21
    v_lshrrev_b32 v22, 3, v1
    v_lshl_add_u32 v21, v22, 7, v21
    s_lshl_b32 s66, s3, 13
    v_add_u32 v20, s66, v20
    v_add_u32 v21, s66, v21
    v_xor_b32 v22, 64, v21
    s_lshl_b32 s66, s3, 2
    v_add_u32 v23, s66, v30
    s_mov_b32 s53, 0x400000
    s_nop 0
L_a_lw:
    ds_read_b32 v31, v30 offset:16
    s_waitcnt lgkmcnt(0)
    v_cmp_eq_u32 vcc, 1, v31
    s_nop 4
    s_cbranch_vccnz L_a_lk
    s_sleep 1
    s_sub_u32 s53, s53, 1
    s_cbranch_scc0 L_a_lw
L_a_lk:
    ds_read_b64_tr_b16 v[200:201], v20 offset:4096
    ds_read_b64_tr_b16 v[202:203], v20 offset:4160
    ds_read_b64_tr_b16 v[204:205], v20 offset:5120
    ds_read_b64_tr_b16 v[206:207], v20 offset:5184
    ds_read_b64_tr_b16 v[208:209], v20 offset:6144
    ds_read_b64_tr_b16 v[210:211], v20 offset:6208
    ds_read_b64_tr_b16 v[212:213], v20 offset:7168
    ds_read_b64_tr_b16 v[214:215], v20 offset:7232
    ds_read_b64_tr_b16 v[216:217], v20 offset:8192
    ds_read_b64_tr_b16 v[218:219], v20 offset:8256
    ds_read_b64_tr_b16 v[220:221], v20 offset:9216
    ds_read_b64_tr_b16 v[222:223], v20 offset:9280
    ds_read_b64_tr_b16 v[224:225], v20 offset:10240
    ds_read_b64_tr_b16 v[226:227], v20 offset:10304
    ds_read_b64_tr_b16 v[228:229], v20 offset:11264
    ds_read_b64_tr_b16 v[230:231], v20 offset:11328
    s_waitcnt lgkmcnt(14)
    ds_write_b128 v21, v[200:203] offset:4096
    s_waitcnt lgkmcnt(13)
    ds_write_b128 v22, v[204:207] offset:5120
    s_waitcnt lgkmcnt(12)
    ds_write_b128 v21, v[208:211] offset:6144
    s_waitcnt lgkmcnt(11)
    ds_write_b128 v22, v[212:215] offset:7168
    s_waitcnt lgkmcnt(10)
    ds_write_b128 v21, v[216:219] offset:8192
    s_waitcnt lgkmcnt(9)
    ds_write_b128 v22, v[220:223] offset:9216
    s_waitcnt lgkmcnt(8)
    ds_write_b128 v21, v[224:227] offset:10240
    s_waitcnt lgkmcnt(7)
    ds_write_b128 v22, v[228:231] offset:11264
    ds_write_b32 v23, v31
L_a_nt:
    s_mov_b32 s53, 0x400000
L_a_uw:
    ds_read_b128 v[20:23], v30
    s_waitcnt lgkmcnt(0)
    v_min3_u32 v20, v20, v21, v22
    v_min_u32 v31, v20, v23
    v_cmp_eq_u32 vcc, 1, v31
    s_nop 4
    s_cbranch_vccnz L_a_uk
    s_sleep 1
    s_sub_u32 s53, s53, 1
    s_cbranch_scc0 L_a_uw
L_a_uk:
    s_setprio 0
    s_and_b32 s66, s4, 7
    s_lshl_b32 s66, s66, 1
    s_lshr_b32 s67, s3, 2
    s_add_u32 s66, s66, s67
    s_mul_i32 s66, s66, 294912
    s_lshl_b32 s67, s6, 15
    s_add_u32 s66, s66, s67
    s_and_b32 s67, s3, 3
    s_lshl_b32 s67, s67, 13
    s_add_u32 s66, s66, s67
    s_add_u32 s66, s66, 1048576
    v_lshlrev_b32 v255, 7, v1
    buffer_load_dword v252, v255, s[40:43], s66 offen
    v_lshlrev_b32 v24, 4, v1
    v_add_u32 v24, 148480, v24
    ds_read_b128 v[176:179], v24 offset:0
    ds_read_b128 v[180:183], v24 offset:1024
    ds_read_b128 v[184:187], v24 offset:2048
    ds_read_b128 v[188:191], v24 offset:3072
    ds_read_b128 v[192:195], v24 offset:4096
    ds_read_b128 v[196:199], v24 offset:5120
    ds_read_b128 v[132:135], v24 offset:6144
    ds_read_b128 v[200:203], v10 offset:256
    ds_read_b128 v[204:207], v11 offset:768
    ds_read_b128 v[208:211], v12 offset:1280
    ds_read_b128 v[212:215], v13 offset:1792
    s_waitcnt lgkmcnt(3)
    v_lshl_or_b32 v29, v29, 16, v29
    v_and_b32 v132, v29, v132
    v_and_b32 v133, v29, v133
    v_and_b32 v134, v29, v134
    v_and_b32 v135, v29, v135
    v_mfma_f32_16x16x32_bf16 v[32:35], v[92:95], v[200:203], 0
    ds_read_b128 v[216:219], v10 offset:2304
    v_mfma_f32_16x16x32_bf16 v[36:39], v[124:127], v[200:203], 0
    s_waitcnt lgkmcnt(3)
    v_mfma_f32_16x16x32_bf16 v[32:35], v[88:91], v[204:207], v[32:35]
    ds_read_b128 v[220:223], v11 offset:2816
    v_mfma_f32_16x16x32_bf16 v[36:39], v[120:123], v[204:207], v[36:39]
    s_waitcnt lgkmcnt(3)
    v_mfma_f32_16x16x32_bf16 v[32:35], v[84:87], v[208:211], v[32:35]
    ds_read_b128 v[200:203], v12 offset:3328
    v_mfma_f32_16x16x32_bf16 v[36:39], v[116:119], v[208:211], v[36:39]
    s_waitcnt lgkmcnt(3)
    v_mfma_f32_16x16x32_bf16 v[32:35], v[80:83], v[212:215], v[32:35]
    ds_read_b128 v[204:207], v13 offset:3840
    ds_read_b128 v[224:227], v14 offset:3712
    v_mfma_f32_16x16x32_bf16 v[36:39], v[112:115], v[212:215], v[36:39]
    s_waitcnt lgkmcnt(4)
    v_mfma_f32_16x16x32_bf16 v[32:35], v[76:79], v[216:219], v[32:35]
    ds_read_b128 v[208:211], v10 offset:4352
    v_mfma_f32_16x16x32_bf16 v[36:39], v[108:111], v[216:219], v[36:39]
    s_waitcnt lgkmcnt(4)
    v_mfma_f32_16x16x32_bf16 v[32:35], v[72:75], v[220:223], v[32:35]
    ds_read_b128 v[212:215], v11 offset:4864
    v_mfma_f32_16x16x32_bf16 v[36:39], v[104:107], v[220:223], v[36:39]
    s_waitcnt lgkmcnt(4)
    v_mfma_f32_16x16x32_bf16 v[32:35], v[68:71], v[200:203], v[32:35]
    ds_read_b128 v[216:219], v12 offset:5376
    v_mfma_f32_16x16x32_bf16 v[36:39], v[100:103], v[200:203], v[36:39]
    s_waitcnt lgkmcnt(4)
    v_mfma_f32_16x16x32_bf16 v[32:35], v[64:67], v[204:207], v[32:35]
    ds_read_b128 v[220:223], v13 offset:5888
    v_mfma_f32_16x16x32_bf16 v[36:39], v[96:99], v[204:207], v[36:39]
    v_mfma_f32_16x16x32_bf16 v[40:43], v[128:131], v[204:207], 0
    v_mfma_f32_16x16x32_bf16 v[48:51], v[132:135], v[204:207], 0
    s_waitcnt lgkmcnt(4)
    v_mfma_f32_16x16x32_bf16 v[228:231], v[204:207], v[176:179], 0
    v_mfma_f32_16x16x32_bf16 v[232:235], v[204:207], v[180:183], 0
    v_mfma_f32_16x16x32_bf16 v[236:239], v[204:207], v[184:187], 0
    v_mfma_f32_16x16x32_bf16 v[240:243], v[224:227], v[188:191], 0
    v_mfma_f32_16x16x32_bf16 v[244:247], v[204:207], v[192:195], 0
    v_mfma_f32_16x16x32_bf16 v[248:251], v[224:227], v[196:199], 0
    s_waitcnt lgkmcnt(3)
    v_mfma_f32_16x16x32_bf16 v[36:39], v[92:95], v[208:211], v[36:39]
    ds_read_b128 v[200:203], v10 offset:6400
    v_mfma_f32_16x16x32_bf16 v[40:43], v[124:127], v[208:211], v[40:43]
    s_waitcnt lgkmcnt(3)
    v_mfma_f32_16x16x32_bf16 v[36:39], v[88:91], v[212:215], v[36:39]
    ds_read_b128 v[204:207], v11 offset:6912
    v_mfma_f32_16x16x32_bf16 v[40:43], v[120:123], v[212:215], v[40:43]
    v_cvt_pk_bf16_f32 v24, v240, v236
    v_cvt_pk_bf16_f32 v25, v232, v228
    v_cvt_pk_bf16_f32 v26, v241, v237
    v_cvt_pk_bf16_f32 v27, v233, v229
    s_waitcnt lgkmcnt(3)
    v_mfma_f32_16x16x32_bf16 v[36:39], v[84:87], v[216:219], v[36:39]
    ds_read_b128 v[208:211], v12 offset:7424
    v_mfma_f32_16x16x32_bf16 v[40:43], v[116:119], v[216:219], v[40:43]
    v_cvt_pk_bf16_f32 v32, v32, v33
    v_cvt_pk_bf16_f32 v33, v34, v35
    v_mov_b32 v17, 1
    ds_write_b64 v15, v[32:33] offset:0
    ds_write_b32 v16, v17
    v_cvt_pk_bf16_f32 v28, v242, v238
    v_cvt_pk_bf16_f32 v29, v234, v230
    v_cvt_pk_bf16_f32 v30, v243, v239
    v_cvt_pk_bf16_f32 v31, v235, v231
    s_waitcnt lgkmcnt(5)
    v_mfma_f32_16x16x32_bf16 v[36:39], v[80:83], v[220:223], v[36:39]
    ds_read_b128 v[212:215], v13 offset:7936
    ds_read_b128 v[224:227], v14 offset:7808
    v_mfma_f32_16x16x32_bf16 v[40:43], v[112:115], v[220:223], v[40:43]
    v_cvt_pk_bf16_f32 v20, v248, v244
    v_cvt_pk_bf16_f32 v21, v249, v245
    v_cvt_pk_bf16_f32 v22, v250, v246
    v_cvt_pk_bf16_f32 v23, v251, v247
    s_waitcnt lgkmcnt(6)
    v_mfma_f32_16x16x32_bf16 v[36:39], v[76:79], v[200:203], v[36:39]
    ds_read_b128 v[216:219], v10 offset:8448
    v_mfma_f32_16x16x32_bf16 v[40:43], v[108:111], v[200:203], v[40:43]
    v_mfma_f32_16x16x32_bf16 v[40:43], v[24:27], v[152:155], v[40:43]
    v_mfma_f32_16x16x32_bf16 v[44:47], v[28:31], v[164:167], 0
    v_mfma_f32_16x16x32_bf16 v[48:51], v[20:23], v[136:139], v[48:51]
    v_mfma_f32_16x16x32_bf16 v[60:63], v[20:23], v[148:151], 0
    s_waitcnt lgkmcnt(6)
    v_mfma_f32_16x16x32_bf16 v[36:39], v[72:75], v[204:207], v[36:39]
    ds_read_b128 v[220:223], v11 offset:8960
    v_mfma_f32_16x16x32_bf16 v[40:43], v[104:107], v[204:207], v[40:43]
    v_mfma_f32_16x16x32_bf16 v[40:43], v[28:31], v[156:159], v[40:43]
    v_mfma_f32_16x16x32_bf16 v[48:51], v[24:27], v[168:171], v[48:51]
    v_mfma_f32_16x16x32_bf16 v[52:55], v[20:23], v[140:143], 0
    s_waitcnt lgkmcnt(6)
    v_mfma_f32_16x16x32_bf16 v[36:39], v[68:71], v[208:211], v[36:39]
    ds_read_b128 v[200:203], v12 offset:9472
    v_mfma_f32_16x16x32_bf16 v[40:43], v[100:103], v[208:211], v[40:43]
    v_mfma_f32_16x16x32_bf16 v[44:47], v[24:27], v[160:163], v[44:47]
    v_mfma_f32_16x16x32_bf16 v[48:51], v[28:31], v[172:175], v[48:51]
    v_mfma_f32_16x16x32_bf16 v[56:59], v[20:23], v[144:147], 0
    s_waitcnt lgkmcnt(4)
    v_mfma_f32_16x16x32_bf16 v[36:39], v[64:67], v[212:215], v[36:39]
    ds_read_b128 v[204:207], v13 offset:9984
    v_mfma_f32_16x16x32_bf16 v[40:43], v[96:99], v[212:215], v[40:43]
    v_mfma_f32_16x16x32_bf16 v[44:47], v[128:131], v[212:215], v[44:47]
    v_mfma_f32_16x16x32_bf16 v[52:55], v[132:135], v[212:215], v[52:55]
    s_waitcnt lgkmcnt(4)
    v_mfma_f32_16x16x32_bf16 v[228:231], v[212:215], v[176:179], 0
    v_mfma_f32_16x16x32_bf16 v[232:235], v[212:215], v[180:183], 0
    v_mfma_f32_16x16x32_bf16 v[236:239], v[212:215], v[184:187], 0
    v_mfma_f32_16x16x32_bf16 v[240:243], v[224:227], v[188:191], 0
    v_mfma_f32_16x16x32_bf16 v[244:247], v[212:215], v[192:195], 0
    v_mfma_f32_16x16x32_bf16 v[248:251], v[224:227], v[196:199], 0
    s_waitcnt lgkmcnt(3)
    v_mfma_f32_16x16x32_bf16 v[40:43], v[92:95], v[216:219], v[40:43]
    ds_read_b128 v[208:211], v10 offset:10496
    v_mfma_f32_16x16x32_bf16 v[44:47], v[124:127], v[216:219], v[44:47]
    s_waitcnt lgkmcnt(3)
    v_mfma_f32_16x16x32_bf16 v[40:43], v[88:91], v[220:223], v[40:43]
    ds_read_b128 v[212:215], v11 offset:11008
    v_mfma_f32_16x16x32_bf16 v[44:47], v[120:123], v[220:223], v[44:47]
    v_cvt_pk_bf16_f32 v24, v240, v236
    v_cvt_pk_bf16_f32 v25, v232, v228
    v_cvt_pk_bf16_f32 v26, v241, v237
    v_cvt_pk_bf16_f32 v27, v233, v229
    s_waitcnt lgkmcnt(3)
    v_mfma_f32_16x16x32_bf16 v[40:43], v[84:87], v[200:203], v[40:43]
    ds_read_b128 v[216:219], v12 offset:11520
    v_mfma_f32_16x16x32_bf16 v[44:47], v[116:119], v[200:203], v[44:47]
    v_cvt_pk_bf16_f32 v36, v36, v37
    v_cvt_pk_bf16_f32 v37, v38, v39
    v_mov_b32 v17, 2
    ds_write_b64 v15, v[36:37] offset:4096
    ds_write_b32 v16, v17
    v_cvt_pk_bf16_f32 v28, v242, v238
    v_cvt_pk_bf16_f32 v29, v234, v230
    v_cvt_pk_bf16_f32 v30, v243, v239
    v_cvt_pk_bf16_f32 v31, v235, v231
    s_waitcnt lgkmcnt(5)
    v_mfma_f32_16x16x32_bf16 v[40:43], v[80:83], v[204:207], v[40:43]
    ds_read_b128 v[220:223], v13 offset:12032
    ds_read_b128 v[224:227], v14 offset:11904
    v_mfma_f32_16x16x32_bf16 v[44:47], v[112:115], v[204:207], v[44:47]
    v_cvt_pk_bf16_f32 v20, v248, v244
    v_cvt_pk_bf16_f32 v21, v249, v245
    v_cvt_pk_bf16_f32 v22, v250, v246
    v_cvt_pk_bf16_f32 v23, v251, v247
    s_waitcnt lgkmcnt(6)
    v_mfma_f32_16x16x32_bf16 v[40:43], v[76:79], v[208:211], v[40:43]
    ds_read_b128 v[200:203], v10 offset:12544
    v_mfma_f32_16x16x32_bf16 v[44:47], v[108:111], v[208:211], v[44:47]
    v_mfma_f32_16x16x32_bf16 v[44:47], v[24:27], v[152:155], v[44:47]
    v_mfma_f32_16x16x32_bf16 v[48:51], v[28:31], v[164:167], v[48:51]
    v_mfma_f32_16x16x32_bf16 v[52:55], v[20:23], v[136:139], v[52:55]
    s_waitcnt lgkmcnt(6)
    v_mfma_f32_16x16x32_bf16 v[40:43], v[72:75], v[212:215], v[40:43]
    ds_read_b128 v[204:207], v11 offset:13056
    v_mfma_f32_16x16x32_bf16 v[44:47], v[104:107], v[212:215], v[44:47]
    v_mfma_f32_16x16x32_bf16 v[44:47], v[28:31], v[156:159], v[44:47]
    v_mfma_f32_16x16x32_bf16 v[52:55], v[24:27], v[168:171], v[52:55]
    v_mfma_f32_16x16x32_bf16 v[56:59], v[20:23], v[140:143], v[56:59]
    s_waitcnt lgkmcnt(6)
    v_mfma_f32_16x16x32_bf16 v[40:43], v[68:71], v[216:219], v[40:43]
    ds_read_b128 v[208:211], v12 offset:13568
    v_mfma_f32_16x16x32_bf16 v[44:47], v[100:103], v[216:219], v[44:47]
    v_mfma_f32_16x16x32_bf16 v[48:51], v[24:27], v[160:163], v[48:51]
    v_mfma_f32_16x16x32_bf16 v[52:55], v[28:31], v[172:175], v[52:55]
    v_mfma_f32_16x16x32_bf16 v[60:63], v[20:23], v[144:147], v[60:63]
    s_waitcnt lgkmcnt(4)
    v_mfma_f32_16x16x32_bf16 v[40:43], v[64:67], v[220:223], v[40:43]
    ds_read_b128 v[212:215], v13 offset:14080
    v_mfma_f32_16x16x32_bf16 v[44:47], v[96:99], v[220:223], v[44:47]
    v_mfma_f32_16x16x32_bf16 v[48:51], v[128:131], v[220:223], v[48:51]
    v_mfma_f32_16x16x32_bf16 v[56:59], v[132:135], v[220:223], v[56:59]
    s_waitcnt lgkmcnt(4)
    v_mfma_f32_16x16x32_bf16 v[228:231], v[220:223], v[176:179], 0
    v_mfma_f32_16x16x32_bf16 v[232:235], v[220:223], v[180:183], 0
    v_mfma_f32_16x16x32_bf16 v[236:239], v[220:223], v[184:187], 0
    v_mfma_f32_16x16x32_bf16 v[240:243], v[224:227], v[188:191], 0
    v_mfma_f32_16x16x32_bf16 v[244:247], v[220:223], v[192:195], 0
    v_mfma_f32_16x16x32_bf16 v[248:251], v[224:227], v[196:199], 0
    s_waitcnt lgkmcnt(3)
    v_mfma_f32_16x16x32_bf16 v[44:47], v[92:95], v[200:203], v[44:47]
    ds_read_b128 v[216:219], v10 offset:14592
    v_mfma_f32_16x16x32_bf16 v[48:51], v[124:127], v[200:203], v[48:51]
    s_waitcnt lgkmcnt(3)
    v_mfma_f32_16x16x32_bf16 v[44:47], v[88:91], v[204:207], v[44:47]
    ds_read_b128 v[220:223], v11 offset:15104
    v_mfma_f32_16x16x32_bf16 v[48:51], v[120:123], v[204:207], v[48:51]
    v_cvt_pk_bf16_f32 v24, v240, v236
    v_cvt_pk_bf16_f32 v25, v232, v228
    v_cvt_pk_bf16_f32 v26, v241, v237
    v_cvt_pk_bf16_f32 v27, v233, v229
    s_waitcnt lgkmcnt(3)
    v_mfma_f32_16x16x32_bf16 v[44:47], v[84:87], v[208:211], v[44:47]
    ds_read_b128 v[200:203], v12 offset:15616
    v_mfma_f32_16x16x32_bf16 v[48:51], v[116:119], v[208:211], v[48:51]
    v_cvt_pk_bf16_f32 v40, v40, v41
    v_cvt_pk_bf16_f32 v41, v42, v43
    v_mov_b32 v17, 3
    ds_write_b64 v15, v[40:41] offset:8192
    ds_write_b32 v16, v17
    v_cvt_pk_bf16_f32 v28, v242, v238
    v_cvt_pk_bf16_f32 v29, v234, v230
    v_cvt_pk_bf16_f32 v30, v243, v239
    v_cvt_pk_bf16_f32 v31, v235, v231
    s_waitcnt lgkmcnt(5)
    v_mfma_f32_16x16x32_bf16 v[44:47], v[80:83], v[212:215], v[44:47]
    ds_read_b128 v[204:207], v13 offset:16128
    ds_read_b128 v[224:227], v14 offset:16000
    v_mfma_f32_16x16x32_bf16 v[48:51], v[112:115], v[212:215], v[48:51]
    v_cvt_pk_bf16_f32 v20, v248, v244
    v_cvt_pk_bf16_f32 v21, v249, v245
    v_cvt_pk_bf16_f32 v22, v250, v246
    v_cvt_pk_bf16_f32 v23, v251, v247
    s_waitcnt lgkmcnt(6)
    v_mfma_f32_16x16x32_bf16 v[44:47], v[76:79], v[216:219], v[44:47]
    ds_read_b128 v[208:211], v10 offset:16640
    v_mfma_f32_16x16x32_bf16 v[48:51], v[108:111], v[216:219], v[48:51]
    v_mfma_f32_16x16x32_bf16 v[48:51], v[24:27], v[152:155], v[48:51]
    v_mfma_f32_16x16x32_bf16 v[52:55], v[28:31], v[164:167], v[52:55]
    v_mfma_f32_16x16x32_bf16 v[56:59], v[20:23], v[136:139], v[56:59]
    s_waitcnt lgkmcnt(6)
    v_mfma_f32_16x16x32_bf16 v[44:47], v[72:75], v[220:223], v[44:47]
    ds_read_b128 v[212:215], v11 offset:17152
    v_mfma_f32_16x16x32_bf16 v[48:51], v[104:107], v[220:223], v[48:51]
    v_mfma_f32_16x16x32_bf16 v[48:51], v[28:31], v[156:159], v[48:51]
    v_mfma_f32_16x16x32_bf16 v[56:59], v[24:27], v[168:171], v[56:59]
    v_mfma_f32_16x16x32_bf16 v[60:63], v[20:23], v[140:143], v[60:63]
    s_waitcnt lgkmcnt(6)
    v_mfma_f32_16x16x32_bf16 v[44:47], v[68:71], v[200:203], v[44:47]
    ds_read_b128 v[216:219], v12 offset:17664
    v_mfma_f32_16x16x32_bf16 v[48:51], v[100:103], v[200:203], v[48:51]
    v_mfma_f32_16x16x32_bf16 v[52:55], v[24:27], v[160:163], v[52:55]
    v_mfma_f32_16x16x32_bf16 v[56:59], v[28:31], v[172:175], v[56:59]
    s_waitcnt lgkmcnt(4)
    v_mfma_f32_16x16x32_bf16 v[44:47], v[64:67], v[204:207], v[44:47]
    ds_read_b128 v[220:223], v13 offset:18176
    v_mfma_f32_16x16x32_bf16 v[48:51], v[96:99], v[204:207], v[48:51]
    v_mfma_f32_16x16x32_bf16 v[52:55], v[128:131], v[204:207], v[52:55]
    v_mfma_f32_16x16x32_bf16 v[60:63], v[132:135], v[204:207], v[60:63]
    s_waitcnt lgkmcnt(4)
    v_mfma_f32_16x16x32_bf16 v[228:231], v[204:207], v[176:179], 0
    v_mfma_f32_16x16x32_bf16 v[232:235], v[204:207], v[180:183], 0
    v_mfma_f32_16x16x32_bf16 v[236:239], v[204:207], v[184:187], 0
    v_mfma_f32_16x16x32_bf16 v[240:243], v[224:227], v[188:191], 0
    v_mfma_f32_16x16x32_bf16 v[244:247], v[204:207], v[192:195], 0
    v_mfma_f32_16x16x32_bf16 v[248:251], v[224:227], v[196:199], 0
    s_waitcnt lgkmcnt(3)
    v_mfma_f32_16x16x32_bf16 v[48:51], v[92:95], v[208:211], v[48:51]
    ds_read_b128 v[200:203], v10 offset:18688
    v_mfma_f32_16x16x32_bf16 v[52:55], v[124:127], v[208:211], v[52:55]
    s_waitcnt lgkmcnt(3)
    v_mfma_f32_16x16x32_bf16 v[48:51], v[88:91], v[212:215], v[48:51]
    ds_read_b128 v[204:207], v11 offset:19200
    v_mfma_f32_16x16x32_bf16 v[52:55], v[120:123], v[212:215], v[52:55]
    v_cvt_pk_bf16_f32 v24, v240, v236
    v_cvt_pk_bf16_f32 v25, v232, v228
    v_cvt_pk_bf16_f32 v26, v241, v237
    v_cvt_pk_bf16_f32 v27, v233, v229
    s_waitcnt lgkmcnt(3)
    v_mfma_f32_16x16x32_bf16 v[48:51], v[84:87], v[216:219], v[48:51]
    ds_read_b128 v[208:211], v12 offset:19712
    v_mfma_f32_16x16x32_bf16 v[52:55], v[116:119], v[216:219], v[52:55]
    v_cvt_pk_bf16_f32 v44, v44, v45
    v_cvt_pk_bf16_f32 v45, v46, v47
    v_mov_b32 v17, 4
    ds_write_b64 v15, v[44:45] offset:12288
    ds_write_b32 v16, v17
    v_cvt_pk_bf16_f32 v28, v242, v238
    v_cvt_pk_bf16_f32 v29, v234, v230
    v_cvt_pk_bf16_f32 v30, v243, v239
    v_cvt_pk_bf16_f32 v31, v235, v231
    s_waitcnt lgkmcnt(5)
    v_mfma_f32_16x16x32_bf16 v[48:51], v[80:83], v[220:223], v[48:51]
    ds_read_b128 v[212:215], v13 offset:20224
    ds_read_b128 v[224:227], v14 offset:20096
    v_mfma_f32_16x16x32_bf16 v[52:55], v[112:115], v[220:223], v[52:55]
    v_cvt_pk_bf16_f32 v20, v248, v244
    v_cvt_pk_bf16_f32 v21, v249, v245
    v_cvt_pk_bf16_f32 v22, v250, v246
    v_cvt_pk_bf16_f32 v23, v251, v247
    s_waitcnt lgkmcnt(6)
    v_mfma_f32_16x16x32_bf16 v[48:51], v[76:79], v[200:203], v[48:51]
    ds_read_b128 v[216:219], v10 offset:20736
    v_mfma_f32_16x16x32_bf16 v[52:55], v[108:111], v[200:203], v[52:55]
    v_mfma_f32_16x16x32_bf16 v[52:55], v[24:27], v[152:155], v[52:55]
    v_mfma_f32_16x16x32_bf16 v[56:59], v[28:31], v[164:167], v[56:59]
    v_mfma_f32_16x16x32_bf16 v[60:63], v[20:23], v[136:139], v[60:63]
    s_waitcnt lgkmcnt(6)
    v_mfma_f32_16x16x32_bf16 v[48:51], v[72:75], v[204:207], v[48:51]
    ds_read_b128 v[220:223], v11 offset:21248
    v_mfma_f32_16x16x32_bf16 v[52:55], v[104:107], v[204:207], v[52:55]
    v_mfma_f32_16x16x32_bf16 v[52:55], v[28:31], v[156:159], v[52:55]
    v_mfma_f32_16x16x32_bf16 v[60:63], v[24:27], v[168:171], v[60:63]
    s_waitcnt lgkmcnt(6)
    v_mfma_f32_16x16x32_bf16 v[48:51], v[68:71], v[208:211], v[48:51]
    ds_read_b128 v[200:203], v12 offset:21760
    v_mfma_f32_16x16x32_bf16 v[52:55], v[100:103], v[208:211], v[52:55]
    v_mfma_f32_16x16x32_bf16 v[56:59], v[24:27], v[160:163], v[56:59]
    v_mfma_f32_16x16x32_bf16 v[60:63], v[28:31], v[172:175], v[60:63]
    s_waitcnt lgkmcnt(4)
    v_mfma_f32_16x16x32_bf16 v[48:51], v[64:67], v[212:215], v[48:51]
    ds_read_b128 v[204:207], v13 offset:22272
    v_mfma_f32_16x16x32_bf16 v[52:55], v[96:99], v[212:215], v[52:55]
    v_mfma_f32_16x16x32_bf16 v[56:59], v[128:131], v[212:215], v[56:59]
    s_waitcnt lgkmcnt(4)
    v_mfma_f32_16x16x32_bf16 v[228:231], v[212:215], v[176:179], 0
    v_mfma_f32_16x16x32_bf16 v[232:235], v[212:215], v[180:183], 0
    v_mfma_f32_16x16x32_bf16 v[236:239], v[212:215], v[184:187], 0
    v_mfma_f32_16x16x32_bf16 v[240:243], v[224:227], v[188:191], 0
    s_waitcnt lgkmcnt(3)
    v_mfma_f32_16x16x32_bf16 v[52:55], v[92:95], v[216:219], v[52:55]
    ds_read_b128 v[208:211], v10 offset:22784
    v_mfma_f32_16x16x32_bf16 v[56:59], v[124:127], v[216:219], v[56:59]
    s_waitcnt lgkmcnt(3)
    v_mfma_f32_16x16x32_bf16 v[52:55], v[88:91], v[220:223], v[52:55]
    ds_read_b128 v[212:215], v11 offset:23296
    v_mfma_f32_16x16x32_bf16 v[56:59], v[120:123], v[220:223], v[56:59]
    v_cvt_pk_bf16_f32 v24, v240, v236
    v_cvt_pk_bf16_f32 v25, v232, v228
    v_cvt_pk_bf16_f32 v26, v241, v237
    v_cvt_pk_bf16_f32 v27, v233, v229
    s_waitcnt lgkmcnt(3)
    v_mfma_f32_16x16x32_bf16 v[52:55], v[84:87], v[200:203], v[52:55]
    ds_read_b128 v[216:219], v12 offset:23808
    v_mfma_f32_16x16x32_bf16 v[56:59], v[116:119], v[200:203], v[56:59]
    v_cvt_pk_bf16_f32 v48, v48, v49
    v_cvt_pk_bf16_f32 v49, v50, v51
    v_mov_b32 v17, 5
    ds_write_b64 v15, v[48:49] offset:16384
    ds_write_b32 v16, v17
    v_cvt_pk_bf16_f32 v28, v242, v238
    v_cvt_pk_bf16_f32 v29, v234, v230
    v_cvt_pk_bf16_f32 v30, v243, v239
    v_cvt_pk_bf16_f32 v31, v235, v231
    s_waitcnt lgkmcnt(5)
    v_mfma_f32_16x16x32_bf16 v[52:55], v[80:83], v[204:207], v[52:55]
    ds_read_b128 v[220:223], v13 offset:24320
    ds_read_b128 v[224:227], v14 offset:24192
    v_mfma_f32_16x16x32_bf16 v[56:59], v[112:115], v[204:207], v[56:59]
    s_waitcnt lgkmcnt(6)
    v_mfma_f32_16x16x32_bf16 v[52:55], v[76:79], v[208:211], v[52:55]
    ds_read_b128 v[200:203], v10 offset:24832
    v_mfma_f32_16x16x32_bf16 v[56:59], v[108:111], v[208:211], v[56:59]
    v_mfma_f32_16x16x32_bf16 v[56:59], v[24:27], v[152:155], v[56:59]
    v_mfma_f32_16x16x32_bf16 v[60:63], v[28:31], v[164:167], v[60:63]
    s_waitcnt lgkmcnt(6)
    v_mfma_f32_16x16x32_bf16 v[52:55], v[72:75], v[212:215], v[52:55]
    ds_read_b128 v[204:207], v11 offset:25344
    v_mfma_f32_16x16x32_bf16 v[56:59], v[104:107], v[212:215], v[56:59]
    v_mfma_f32_16x16x32_bf16 v[56:59], v[28:31], v[156:159], v[56:59]
    s_waitcnt lgkmcnt(6)
    v_mfma_f32_16x16x32_bf16 v[52:55], v[68:71], v[216:219], v[52:55]
    ds_read_b128 v[208:211], v12 offset:25856
    v_mfma_f32_16x16x32_bf16 v[56:59], v[100:103], v[216:219], v[56:59]
    v_mfma_f32_16x16x32_bf16 v[60:63], v[24:27], v[160:163], v[60:63]
    s_waitcnt lgkmcnt(4)
    v_mfma_f32_16x16x32_bf16 v[52:55], v[64:67], v[220:223], v[52:55]
    ds_read_b128 v[212:215], v13 offset:26368
    v_mfma_f32_16x16x32_bf16 v[56:59], v[96:99], v[220:223], v[56:59]
    v_mfma_f32_16x16x32_bf16 v[60:63], v[128:131], v[220:223], v[60:63]
    s_waitcnt lgkmcnt(4)
    v_mfma_f32_16x16x32_bf16 v[228:231], v[220:223], v[176:179], 0
    v_mfma_f32_16x16x32_bf16 v[232:235], v[220:223], v[180:183], 0
    v_mfma_f32_16x16x32_bf16 v[236:239], v[220:223], v[184:187], 0
    v_mfma_f32_16x16x32_bf16 v[240:243], v[224:227], v[188:191], 0
    s_waitcnt lgkmcnt(3)
    v_mfma_f32_16x16x32_bf16 v[56:59], v[92:95], v[200:203], v[56:59]
    ds_read_b128 v[216:219], v10 offset:26880
    v_mfma_f32_16x16x32_bf16 v[60:63], v[124:127], v[200:203], v[60:63]
    s_waitcnt lgkmcnt(3)
    v_mfma_f32_16x16x32_bf16 v[56:59], v[88:91], v[204:207], v[56:59]
    ds_read_b128 v[220:223], v11 offset:27392
    v_mfma_f32_16x16x32_bf16 v[60:63], v[120:123], v[204:207], v[60:63]
    v_cvt_pk_bf16_f32 v24, v240, v236
    v_cvt_pk_bf16_f32 v25, v232, v228
    v_cvt_pk_bf16_f32 v26, v241, v237
    v_cvt_pk_bf16_f32 v27, v233, v229
    s_waitcnt lgkmcnt(3)
    v_mfma_f32_16x16x32_bf16 v[56:59], v[84:87], v[208:211], v[56:59]
    ds_read_b128 v[200:203], v12 offset:27904
    v_mfma_f32_16x16x32_bf16 v[60:63], v[116:119], v[208:211], v[60:63]
    v_cvt_pk_bf16_f32 v52, v52, v53
    v_cvt_pk_bf16_f32 v53, v54, v55
    v_mov_b32 v17, 6
    ds_write_b64 v15, v[52:53] offset:20480
    ds_write_b32 v16, v17
    v_cvt_pk_bf16_f32 v28, v242, v238
    v_cvt_pk_bf16_f32 v29, v234, v230
    v_cvt_pk_bf16_f32 v30, v243, v239
    v_cvt_pk_bf16_f32 v31, v235, v231
    s_waitcnt lgkmcnt(5)
    v_mfma_f32_16x16x32_bf16 v[56:59], v[80:83], v[212:215], v[56:59]
    ds_read_b128 v[204:207], v13 offset:28416
    v_mfma_f32_16x16x32_bf16 v[60:63], v[112:115], v[212:215], v[60:63]
    s_waitcnt lgkmcnt(5)
    v_mfma_f32_16x16x32_bf16 v[56:59], v[76:79], v[216:219], v[56:59]
    ds_read_b128 v[208:211], v10 offset:28928
    v_mfma_f32_16x16x32_bf16 v[60:63], v[108:111], v[216:219], v[60:63]
    v_mfma_f32_16x16x32_bf16 v[60:63], v[24:27], v[152:155], v[60:63]
    s_waitcnt lgkmcnt(5)
    v_mfma_f32_16x16x32_bf16 v[56:59], v[72:75], v[220:223], v[56:59]
    ds_read_b128 v[212:215], v11 offset:29440
    v_mfma_f32_16x16x32_bf16 v[60:63], v[104:107], v[220:223], v[60:63]
    v_mfma_f32_16x16x32_bf16 v[60:63], v[28:31], v[156:159], v[60:63]
    s_waitcnt lgkmcnt(5)
    v_mfma_f32_16x16x32_bf16 v[56:59], v[68:71], v[200:203], v[56:59]
    ds_read_b128 v[216:219], v12 offset:29952
    v_mfma_f32_16x16x32_bf16 v[60:63], v[100:103], v[200:203], v[60:63]
    s_waitcnt lgkmcnt(3)
    v_mfma_f32_16x16x32_bf16 v[56:59], v[64:67], v[204:207], v[56:59]
    ds_read_b128 v[220:223], v13 offset:30464
    v_mfma_f32_16x16x32_bf16 v[60:63], v[96:99], v[204:207], v[60:63]
    s_waitcnt lgkmcnt(3)
    v_mfma_f32_16x16x32_bf16 v[60:63], v[92:95], v[208:211], v[60:63]
    ds_read_b128 v[200:203], v10 offset:30976
    s_waitcnt lgkmcnt(3)
    v_mfma_f32_16x16x32_bf16 v[60:63], v[88:91], v[212:215], v[60:63]
    ds_read_b128 v[204:207], v11 offset:31488
    s_waitcnt lgkmcnt(3)
    v_mfma_f32_16x16x32_bf16 v[60:63], v[84:87], v[216:219], v[60:63]
    ds_read_b128 v[208:211], v12 offset:32000
    v_cvt_pk_bf16_f32 v56, v56, v57
    v_cvt_pk_bf16_f32 v57, v58, v59
    v_mov_b32 v17, 7
    ds_write_b64 v15, v[56:57] offset:24576
    ds_write_b32 v16, v17
    s_waitcnt lgkmcnt(5)
    v_mfma_f32_16x16x32_bf16 v[60:63], v[80:83], v[220:223], v[60:63]
    ds_read_b128 v[212:215], v13 offset:32512
    s_waitcnt lgkmcnt(5)
    v_mfma_f32_16x16x32_bf16 v[60:63], v[76:79], v[200:203], v[60:63]
    s_waitcnt lgkmcnt(4)
    v_mfma_f32_16x16x32_bf16 v[60:63], v[72:75], v[204:207], v[60:63]
    s_waitcnt lgkmcnt(3)
    v_mfma_f32_16x16x32_bf16 v[60:63], v[68:71], v[208:211], v[60:63]
    s_waitcnt lgkmcnt(0)
    v_mfma_f32_16x16x32_bf16 v[60:63], v[64:67], v[212:215], v[60:63]
    s_nop 7
    v_cvt_pk_bf16_f32 v60, v60, v61
    v_cvt_pk_bf16_f32 v61, v62, v63
    v_mov_b32 v17, 8
    ds_write_b64 v15, v[60:61] offset:28672
    ds_write_b32 v16, v17
    s_cmp_ge_u32 s3, 4
    s_cbranch_scc1 L_a_fin
    v_lshrrev_b32 v8, 1, v1
    v_and_b32 v9, 1, v1
    v_bfe_u32 v10, v8, 1, 3
    v_lshlrev_b32 v12, 2, v9
    v_xor_b32 v10, v10, v12
    v_lshlrev_b32 v10, 4, v10
    v_lshl_add_u32 v20, v8, 7, v10
    s_lshl_b32 s66, s3, 12
    s_add_u32 s66, s66, 36864
    v_add_u32 v20, s66, v20
    v_xor_b32 v21, 16, v20
    v_xor_b32 v22, 32, v20
    v_xor_b32 v23, 48, v20
    s_mov_b32 s66, 36864
    v_mul_lo_u32 v11, v8, s66
    v_lshl_add_u32 v11, v9, 4, v11
    s_lshl_b32 s66, s5, 5
    s_mul_i32 s67, s3, 1179648
    s_add_u32 s66, s66, s67
    v_add_u32 v11, s66, v11
    s_mov_b32 s50, 0
    s_mov_b32 s51, 4608
    s_mov_b32 s52, 9216
    s_mov_b32 s53, 13824
    s_mov_b32 s54, 18432
    s_mov_b32 s55, 23040
    s_mov_b32 s56, 27648
    s_mov_b32 s57, 32256
    v_mov_b32 v12, 155680
    s_add_u32 s66, s3, 1
    s_mov_b32 s67, 0x400000
L_a_tw0:
    ds_read_b128 v[24:27], v12
    ds_read_b128 v[28:31], v12 offset:16
    s_waitcnt lgkmcnt(0)
    v_min3_u32 v24, v24, v25, v26
    v_min3_u32 v28, v28, v29, v30
    v_min3_u32 v24, v24, v27, v31
    v_min_u32 v24, v24, v28
    v_cmp_le_u32 vcc, s66, v24
    s_nop 4
    s_cbranch_vccnz L_a_tg0
    s_sleep 1
    s_sub_u32 s67, s67, 1
    s_cbranch_scc0 L_a_tw0
L_a_tg0:
    ds_read_b128 v[64:67], v20 offset:0
    ds_read_b128 v[68:71], v21 offset:0
    ds_read_b128 v[72:75], v22 offset:0
    ds_read_b128 v[76:79], v23 offset:0
    s_waitcnt lgkmcnt(0)
    v_lshlrev_b32 v96, 16, v64
    v_lshlrev_b32 v97, 16, v68
    v_lshlrev_b32 v98, 16, v72
    v_lshlrev_b32 v99, 16, v76
    buffer_store_dwordx4 v[96:99], v11, s[36:39], s50 offen nt
    v_and_b32 v100, 0xffff0000, v64
    v_and_b32 v101, 0xffff0000, v68
    v_and_b32 v102, 0xffff0000, v72
    v_and_b32 v103, 0xffff0000, v76
    buffer_store_dwordx4 v[100:103], v11, s[36:39], s51 offen nt
    v_lshlrev_b32 v104, 16, v65
    v_lshlrev_b32 v105, 16, v69
    v_lshlrev_b32 v106, 16, v73
    v_lshlrev_b32 v107, 16, v77
    buffer_store_dwordx4 v[104:107], v11, s[36:39], s52 offen nt
    v_and_b32 v108, 0xffff0000, v65
    v_and_b32 v109, 0xffff0000, v69
    v_and_b32 v110, 0xffff0000, v73
    v_and_b32 v111, 0xffff0000, v77
    buffer_store_dwordx4 v[108:111], v11, s[36:39], s53 offen nt
    v_lshlrev_b32 v112, 16, v66
    v_lshlrev_b32 v113, 16, v70
    v_lshlrev_b32 v114, 16, v74
    v_lshlrev_b32 v115, 16, v78
    buffer_store_dwordx4 v[112:115], v11, s[36:39], s54 offen nt
    v_and_b32 v116, 0xffff0000, v66
    v_and_b32 v117, 0xffff0000, v70
    v_and_b32 v118, 0xffff0000, v74
    v_and_b32 v119, 0xffff0000, v78
    buffer_store_dwordx4 v[116:119], v11, s[36:39], s55 offen nt
    v_lshlrev_b32 v120, 16, v67
    v_lshlrev_b32 v121, 16, v71
    v_lshlrev_b32 v122, 16, v75
    v_lshlrev_b32 v123, 16, v79
    buffer_store_dwordx4 v[120:123], v11, s[36:39], s56 offen nt
    v_and_b32 v124, 0xffff0000, v67
    v_and_b32 v125, 0xffff0000, v71
    v_and_b32 v126, 0xffff0000, v75
    v_and_b32 v127, 0xffff0000, v79
    buffer_store_dwordx4 v[124:127], v11, s[36:39], s57 offen nt
    v_add_u32 v11, 4718592, v11
    s_add_u32 s66, s3, 5
    s_mov_b32 s67, 0x400000
L_a_tw1:
    ds_read_b128 v[24:27], v12
    ds_read_b128 v[28:31], v12 offset:16
    s_waitcnt lgkmcnt(0)
    v_min3_u32 v24, v24, v25, v26
    v_min3_u32 v28, v28, v29, v30
    v_min3_u32 v24, v24, v27, v31
    v_min_u32 v24, v24, v28
    v_cmp_le_u32 vcc, s66, v24
    s_nop 4
    s_cbranch_vccnz L_a_tg1
    s_sleep 1
    s_sub_u32 s67, s67, 1
    s_cbranch_scc0 L_a_tw1
L_a_tg1:
    ds_read_b128 v[64:67], v20 offset:16384
    ds_read_b128 v[68:71], v21 offset:16384
    ds_read_b128 v[72:75], v22 offset:16384
    ds_read_b128 v[76:79], v23 offset:16384
    s_waitcnt lgkmcnt(0)
    v_lshlrev_b32 v128, 16, v64
    v_lshlrev_b32 v129, 16, v68
    v_lshlrev_b32 v130, 16, v72
    v_lshlrev_b32 v131, 16, v76
    buffer_store_dwordx4 v[128:131], v11, s[36:39], s50 offen nt
    v_and_b32 v132, 0xffff0000, v64
    v_and_b32 v133, 0xffff0000, v68
    v_and_b32 v134, 0xffff0000, v72
    v_and_b32 v135, 0xffff0000, v76
    buffer_store_dwordx4 v[132:135], v11, s[36:39], s51 offen nt
    v_lshlrev_b32 v136, 16, v65
    v_lshlrev_b32 v137, 16, v69
    v_lshlrev_b32 v138, 16, v73
    v_lshlrev_b32 v139, 16, v77
    buffer_store_dwordx4 v[136:139], v11, s[36:39], s52 offen nt
    v_and_b32 v140, 0xffff0000, v65
    v_and_b32 v141, 0xffff0000, v69
    v_and_b32 v142, 0xffff0000, v73
    v_and_b32 v143, 0xffff0000, v77
    buffer_store_dwordx4 v[140:143], v11, s[36:39], s53 offen nt
    v_lshlrev_b32 v144, 16, v66
    v_lshlrev_b32 v145, 16, v70
    v_lshlrev_b32 v146, 16, v74
    v_lshlrev_b32 v147, 16, v78
    buffer_store_dwordx4 v[144:147], v11, s[36:39], s54 offen nt
    v_and_b32 v148, 0xffff0000, v66
    v_and_b32 v149, 0xffff0000, v70
    v_and_b32 v150, 0xffff0000, v74
    v_and_b32 v151, 0xffff0000, v78
    buffer_store_dwordx4 v[148:151], v11, s[36:39], s55 offen nt
    v_lshlrev_b32 v152, 16, v67
    v_lshlrev_b32 v153, 16, v71
    v_lshlrev_b32 v154, 16, v75
    v_lshlrev_b32 v155, 16, v79
    buffer_store_dwordx4 v[152:155], v11, s[36:39], s56 offen nt
    v_and_b32 v156, 0xffff0000, v67
    v_and_b32 v157, 0xffff0000, v71
    v_and_b32 v158, 0xffff0000, v75
    v_and_b32 v159, 0xffff0000, v79
    buffer_store_dwordx4 v[156:159], v11, s[36:39], s57 offen nt
    s_nop 1
L_a_fin:
    s_endpgm
L_a_h0:
    s_setprio 3
    s_add_u32 s66, s6, 0
    s_and_b32 s66, s66, 7
    s_mul_i32 s67, s66, 294912
    s_lshl_b32 s66, s66, 12
    s_add_u32 m0, s66, 4096
    s_nop 0
    buffer_load_dwordx4 v7, s[32:35], s67 offen  lds
    s_add_u32 s67, s67, 73728
    s_add_u32 m0, s66, 5120
    s_nop 0
    buffer_load_dwordx4 v7, s[32:35], s67 offen  lds
    s_add_u32 s67, s67, 73728
    s_add_u32 m0, s66, 6144
    s_nop 0
    buffer_load_dwordx4 v7, s[32:35], s67 offen  lds
    s_add_u32 s67, s67, 73728
    s_add_u32 m0, s66, 7168
    s_nop 0
    buffer_load_dwordx4 v7, s[32:35], s67 offen  lds
    s_mov_b32 m0, s46
    s_branch L_a_r0
L_a_pw:
    s_waitcnt vmcnt(4)
    s_branch L_a_pr
L_a_h1:
    s_add_u32 s66, s6, 1
    s_and_b32 s66, s66, 7
    s_mul_i32 s67, s66, 294912
    s_lshl_b32 s66, s66, 12
    s_add_u32 m0, s66, 4096
    s_nop 0
    buffer_load_dwordx4 v7, s[32:35], s67 offen  lds
    s_add_u32 s67, s67, 73728
    s_add_u32 m0, s66, 5120
    s_nop 0
    buffer_load_dwordx4 v7, s[32:35], s67 offen  lds
    s_add_u32 s67, s67, 73728
    s_add_u32 m0, s66, 6144
    s_nop 0
    buffer_load_dwordx4 v7, s[32:35], s67 offen  lds
    s_add_u32 s67, s67, 73728
    s_add_u32 m0, s66, 7168
    s_nop 0
    buffer_load_dwordx4 v7, s[32:35], s67 offen  lds
    s_add_u32 s66, s6, 2
    s_and_b32 s66, s66, 7
    s_mul_i32 s67, s66, 294912
    s_lshl_b32 s66, s66, 12
    s_add_u32 m0, s66, 4096
    s_nop 0
    buffer_load_dwordx4 v7, s[32:35], s67 offen  lds
    s_add_u32 s67, s67, 73728
    s_add_u32 m0, s66, 5120
    s_nop 0
    buffer_load_dwordx4 v7, s[32:35], s67 offen  lds
    s_add_u32 s67, s67, 73728
    s_add_u32 m0, s66, 6144
    s_nop 0
    buffer_load_dwordx4 v7, s[32:35], s67 offen  lds
    s_add_u32 s67, s67, 73728
    s_add_u32 m0, s66, 7168
    s_nop 0
    buffer_load_dwordx4 v7, s[32:35], s67 offen  lds
    s_mov_b32 m0, s46
    s_branch L_a_r1
L_a_h2:
    s_add_u32 s66, s6, 3
    s_and_b32 s66, s66, 7
    s_mul_i32 s67, s66, 294912
    s_lshl_b32 s66, s66, 12
    s_add_u32 m0, s66, 4096
    s_nop 0
    buffer_load_dwordx4 v7, s[32:35], s67 offen  lds
    s_add_u32 s67, s67, 73728
    s_add_u32 m0, s66, 5120
    s_nop 0
    buffer_load_dwordx4 v7, s[32:35], s67 offen  lds
    s_add_u32 s67, s67, 73728
    s_add_u32 m0, s66, 6144
    s_nop 0
    buffer_load_dwordx4 v7, s[32:35], s67 offen  lds
    s_add_u32 s67, s67, 73728
    s_add_u32 m0, s66, 7168
    s_nop 0
    buffer_load_dwordx4 v7, s[32:35], s67 offen  lds
    s_mov_b32 m0, s46
    s_branch L_a_r2
L_a_h3:
    s_add_u32 s66, s6, 4
    s_and_b32 s66, s66, 7
    s_mul_i32 s67, s66, 294912
    s_lshl_b32 s66, s66, 12
    s_add_u32 m0, s66, 4096
    s_nop 0
    buffer_load_dwordx4 v7, s[32:35], s67 offen  lds
    s_add_u32 s67, s67, 73728
    s_add_u32 m0, s66, 5120
    s_nop 0
    buffer_load_dwordx4 v7, s[32:35], s67 offen  lds
    s_add_u32 s67, s67, 73728
    s_add_u32 m0, s66, 6144
    s_nop 0
    buffer_load_dwordx4 v7, s[32:35], s67 offen  lds
    s_add_u32 s67, s67, 73728
    s_add_u32 m0, s66, 7168
    s_nop 0
    buffer_load_dwordx4 v7, s[32:35], s67 offen  lds
    s_add_u32 s66, s6, 5
    s_and_b32 s66, s66, 7
    s_mul_i32 s67, s66, 294912
    s_lshl_b32 s66, s66, 12
    s_add_u32 m0, s66, 4096
    s_nop 0
    buffer_load_dwordx4 v7, s[32:35], s67 offen  lds
    s_add_u32 s67, s67, 73728
    s_add_u32 m0, s66, 5120
    s_nop 0
    buffer_load_dwordx4 v7, s[32:35], s67 offen  lds
    s_add_u32 s67, s67, 73728
    s_add_u32 m0, s66, 6144
    s_nop 0
    buffer_load_dwordx4 v7, s[32:35], s67 offen  lds
    s_add_u32 s67, s67, 73728
    s_add_u32 m0, s66, 7168
    s_nop 0
    buffer_load_dwordx4 v7, s[32:35], s67 offen  lds
    s_mov_b32 m0, s46
    s_branch L_a_r3
L_a_h4:
    s_add_u32 s66, s6, 6
    s_and_b32 s66, s66, 7
    s_mul_i32 s67, s66, 294912
    s_lshl_b32 s66, s66, 12
    s_add_u32 m0, s66, 4096
    s_nop 0
    buffer_load_dwordx4 v7, s[32:35], s67 offen  lds
    s_add_u32 s67, s67, 73728
    s_add_u32 m0, s66, 5120
    s_nop 0
    buffer_load_dwordx4 v7, s[32:35], s67 offen  lds
    s_add_u32 s67, s67, 73728
    s_add_u32 m0, s66, 6144
    s_nop 0
    buffer_load_dwordx4 v7, s[32:35], s67 offen  lds
    s_add_u32 s67, s67, 73728
    s_add_u32 m0, s66, 7168
    s_nop 0
    buffer_load_dwordx4 v7, s[32:35], s67 offen  lds
    s_add_u32 s66, s6, 7
    s_and_b32 s66, s66, 7
    s_mul_i32 s67, s66, 294912
    s_lshl_b32 s66, s66, 12
    s_add_u32 m0, s66, 4096
    s_nop 0
    buffer_load_dwordx4 v7, s[32:35], s67 offen  lds
    s_add_u32 s67, s67, 73728
    s_add_u32 m0, s66, 5120
    s_nop 0
    buffer_load_dwordx4 v7, s[32:35], s67 offen  lds
    s_add_u32 s67, s67, 73728
    s_add_u32 m0, s66, 6144
    s_nop 0
    buffer_load_dwordx4 v7, s[32:35], s67 offen  lds
    s_add_u32 s67, s67, 73728
    s_add_u32 m0, s66, 7168
    s_nop 0
    buffer_load_dwordx4 v7, s[32:35], s67 offen  lds
    s_mov_b32 m0, s46
    s_branch L_a_r4
L_a_h5:
    s_mov_b32 m0, s46
    v_mov_b32 v20, 155648
    v_mov_b32 v21, 1
    s_waitcnt vmcnt(0)
    ds_write_b32 v20, v21 offset:16
    s_setprio 1
    s_branch L_a_r5
L_trole:
    s_sub_u32 s4, s2, 216
    s_load_dwordx4 s[20:23], s[0:1], 112
    s_load_dwordx2 s[26:27], s[0:1], 160
    s_load_dwordx2 s[24:25], s[0:1], 0
    s_load_dwordx4 s[44:47], s[0:1], 96
    s_lshr_b32 s5, s4, 3
    s_lshl_b32 s5, s5, 3
    s_add_u32 s5, s5, s3
    s_mul_i32 s30, s5, 16640
    v_lshlrev_b32 v2, 7, v1
    s_waitcnt lgkmcnt(0)
    s_mov_b32 s8, s20
    s_and_b32 s9, s21, 0xffff
    s_mov_b32 s10, 0xa2000
    s_mov_b32 s11, 0x00020000
    s_mov_b32 s12, s22
    s_and_b32 s13, s23, 0xffff
    s_mov_b32 s14, 0xa2000
    s_mov_b32 s15, 0x00020000
    s_mov_b32 s16, s26
    s_and_b32 s17, s27, 0xffff
    s_mov_b32 s18, 0x10000000
    s_mov_b32 s19, 0x00020000
    buffer_load_dword v10, v2, s[8:11], s30 offen
    s_add_u32 s31, s30, 8192
    buffer_load_dword v11, v2, s[8:11], s31 offen
    s_add_u32 s31, s30, 16384
    s_mov_b64 exec, 3
    buffer_load_dword v12, v2, s[8:11], s31 offen
    s_mov_b64 exec, -1
    buffer_load_dword v10, v2, s[12:15], s30 offen
    s_add_u32 s31, s30, 8192
    buffer_load_dword v11, v2, s[12:15], s31 offen
    s_add_u32 s31, s30, 16384
    s_mov_b64 exec, 3
    buffer_load_dword v12, v2, s[12:15], s31 offen
    s_mov_b64 exec, -1
    s_endpgm
L_end:
    s_endpgm
L_codeend:
.section .rodata,"a"
.p2align 6
.amdhsa_kernel concat_heads__ssm_conv_s4__ssm_conv_s5__prompt_kernel
  .amdhsa_next_free_vgpr 256
  .amdhsa_next_free_sgpr 102
  .amdhsa_accum_offset 256
  .amdhsa_group_segment_fixed_size 0
  .amdhsa_kernarg_size 168
  .amdhsa_user_sgpr_count 2
  .amdhsa_user_sgpr_kernarg_segment_ptr 1
  .amdhsa_system_sgpr_workgroup_id_x 1
.end_amdhsa_kernel
```
